```python
import torch

def _softmax(x, axis=-1):
    return torch.softmax(x, dim=axis)
def _gelu(x):
    return torch.nn.functional.gelu(x, approximate="tanh")
def _silu(x):
    return torch.nn.functional.silu(x)
def _sigmoid(x):
    return torch.sigmoid(x)
def _layernorm(x, axis=-1, eps=1e-5):
    m = x.mean(dim=axis, keepdim=True)
    v = x.var(dim=axis, keepdim=True, unbiased=False)
    return (x - m) / torch.sqrt(v + eps)
def _scatter_add(tgt, idx, src, axis=0):
    return tgt.clone().index_add_(axis, idx, src)
def _segment_sum(src, seg, n):
    out = torch.zeros((n,) + src.shape[1:], dtype=src.dtype)
    return out.index_add_(0, seg, src)
def _pad(x, pw):
    flat = tuple(v for pair in reversed(pw) for v in pair)
    return torch.nn.functional.pad(x, flat)

kernel_name = 'recurrent_scan__linear_kernel_hedgehog__dense_activation_squared_relu__prompt'

def setup_inputs():

    _w = (lambda a: (lambda t: t.to(torch.bfloat16) if t.is_floating_point() else t)(torch.as_tensor(a)))
    def _A_setup():
        B, S, D, H = 1, 2048, 512, 32
        Dh = D // H
        return {
            "x": _w((lambda *s: torch.randn(*s, dtype=torch.bfloat16) * 0.05)(B, S, D)),
            "wqkv": _w((lambda *s: torch.randn(*s, dtype=torch.bfloat16) * 0.2)(D, 3 * D)),
            "w_phi": _w((lambda *s: torch.randn(*s, dtype=torch.bfloat16) * 0.2)(H, Dh, Dh) * (Dh ** -0.5)),
            "wo": _w((lambda *s: torch.randn(*s, dtype=torch.bfloat16) * 0.05)(D, D)),
        }
    _A_in = _A_setup()

    def _B_setup():
        B, S, D, F = 1, 2048, 512, 1792
        return {
            "x": _w((lambda *s: torch.randn(*s, dtype=torch.bfloat16) * 0.05)(B, S, D)),
            "w1": _w((lambda *s: torch.randn(*s, dtype=torch.bfloat16) * 0.05)(D, F)),
            "b1": _w((lambda *s: torch.randn(*s, dtype=torch.bfloat16) * 0.2)(F)),
            "w2": _w((lambda *s: torch.randn(*s, dtype=torch.bfloat16) * 0.05)(F, D)),
            "b2": _w((lambda *s: torch.randn(*s, dtype=torch.bfloat16) * 0.8)(D)),
        }
    _B_in = _B_setup()

    return {
        "A_x": _A_in["x"],
        "A_wqkv": _A_in["wqkv"],
        "A_w_phi": _A_in["w_phi"],
        "A_wo": _A_in["wo"],
        "B_x": _B_in["x"],
        "B_w1": _B_in["w1"],
        "B_b1": _B_in["b1"],
        "B_w2": _B_in["w2"],
        "B_b2": _B_in["b2"],
    }

def reference(A_x, A_wqkv, A_w_phi, A_wo, B_x, B_w1, B_b1, B_w2, B_b2):
    def _A_ref(x, wqkv, w_phi, wo):
        B, S, D = x.shape
        H = 32; Dh = D // H
        qkv = (lambda x, *d: x.permute(*d))((x @ wqkv).reshape(B, S, 3, H, Dh), 2, 0, 3, 1, 4)
        q, k, v = qkv[0], qkv[1], qkv[2]
        pq = torch.einsum("bhsd,hdf->bhsf", q, w_phi)
        pk = torch.einsum("bhsd,hdf->bhsf", k, w_phi)
        phi_q = torch.concatenate([_softmax(pq, axis=-1), _softmax(-pq, axis=-1)], axis=-1)
        phi_k = torch.concatenate([_softmax(pk, axis=-1), _softmax(-pk, axis=-1)], axis=-1)
        kv = torch.einsum("bhsf,bhsd->bhfd", phi_k, v)
        z  = torch.einsum("bhsf->bhf", phi_k)
        num = torch.einsum("bhqf,bhfd->bhqd", phi_q, kv)
        den = torch.einsum("bhqf,bhf->bhq", phi_q, z)[..., None] + 1e-6
        o = num / den
        return (lambda x, *d: x.permute(*d))(o, 0, 2, 1, 3).reshape(B, S, D) @ wo

    def _B_ref(x, w1, b1, w2, b2):
        h = torch.einsum("bsd,df->bsf", x, w1) + b1
        zero = torch.zeros_like(h)
        r = torch.where(h > zero, h, zero)
        h = r * r
        out = torch.einsum("bsf,fd->bsd", h, w2) + b2
        return out

    x = A_x
    xn = _layernorm(x, axis=-1)
    s = _A_ref(xn, A_wqkv, A_w_phi, A_wo)
    g = _silu(_B_ref(xn, B_w1, B_b1, B_w2, B_b2))
    return x + s * g
```

```asm
; @launch grid=(256,1,1) block=(512,1,1) lds=163840
.amdgcn_target "amdgcn-amd-amdhsa--gfx950"
.text
.globl recurrent_scan__linear_kernel_hedgehog__dense_activation_squared_relu__prompt_kernel
.type recurrent_scan__linear_kernel_hedgehog__dense_activation_squared_relu__prompt_kernel,@function
.p2align 8
recurrent_scan__linear_kernel_hedgehog__dense_activation_squared_relu__prompt_kernel:
    s_cmp_ge_u32 s2, 256
    s_cbranch_scc1 k1_end
    s_load_dwordx4 s[64:67], s[0:1], 0
    s_load_dwordx2 s[20:21], s[0:1], 40
    v_lshrrev_b32 v4, 6, v0
    v_and_b32 v1, 63, v0
    v_readfirstlane_b32 s40, v4
    s_and_b32 s50, s2, 7
    s_lshr_b32 s51, s2, 3
    s_and_b32 s60, s50, 1
    s_lshl_b32 s60, s60, 3
    s_and_b32 s61, s51, 7
    s_add_u32 s41, s60, s61
    s_lshr_b32 s60, s50, 1
    s_lshl_b32 s60, s60, 2
    s_lshr_b32 s61, s51, 3
    s_add_u32 s42, s60, s61
    s_mov_b32 s101, 0
    s_and_b32 s43, s40, 3
    s_lshr_b32 s44, s40, 2
    v_lshrrev_b32 v8, 3, v1
    v_lshlrev_b32 v8, 10, v8
    v_and_b32 v9, 7, v1
    v_lshrrev_b32 v6, 4, v1
    v_xor_b32 v9, v9, v6
    v_lshlrev_b32 v9, 4, v9
    v_add_u32 v8, v8, v9
    v_xor_b32 v9, 64, v8
    v_lshrrev_b32 v10, 2, v1
    v_mul_u32_u24 v10, 3072, v10
    v_and_b32 v6, 3, v1
    v_lshlrev_b32 v6, 4, v6
    v_add_u32 v10, v10, v6
    s_lshl_b32 s52, s41, 17
    s_lshl_b32 s60, s40, 14
    s_add_u32 s52, s52, s60
    s_add_u32 s53, s52, 8192
    s_lshl_b32 s54, s40, 11
    s_mul_i32 s55, s43, 49152
    s_lshl_b32 s60, s42, 6
    s_add_u32 s56, s55, s60
    s_add_u32 s60, s44, 1
    s_lshl_b32 s60, s60, 10
    s_add_u32 s55, s56, s60
    s_lshl_b32 s57, s43, 10
    s_lshl_b32 s51, s43, 11
    s_lshr_b32 s60, s42, 2
    s_mul_i32 s60, s60, 14
    s_and_b32 s61, s42, 3
    s_lshl_b32 s61, s61, 2
    s_add_u32 s45, s60, s61
    v_lshrrev_b32 v11, 3, v1
    v_mul_u32_u24 v11, 3584, v11
    v_add_u32 v11, v11, v6
    v_lshrrev_b32 v6, 2, v1
    v_lshrrev_b32 v7, 4, v1
    v_xor_b32 v6, v6, v7
    v_and_b32 v6, 1, v6
    v_lshlrev_b32 v6, 6, v6
    v_add_u32 v11, v11, v6
    s_mul_i32 s58, s43, 57344
    s_lshl_b32 s60, s45, 6
    s_add_u32 s58, s58, s60
    s_lshl_b32 s60, s44, 7
    s_add_u32 s58, s58, s60
    s_waitcnt lgkmcnt(0)
    s_mov_b32 s22, 1835008
    s_mov_b32 s23, 0x20000
    s_mov_b32 s4, s64
    s_mov_b32 s5, s65
    s_mov_b32 s6, 0x200000
    s_mov_b32 s7, 0x20000
    s_mov_b32 s8, s66
    s_mov_b32 s9, s67
    s_mov_b32 s10, 1572864
    s_mov_b32 s11, 0x20000
    s_load_dwordx2 s[12:13], s[0:1], 16
    s_load_dwordx2 s[16:17], s[0:1], 24
    s_load_dwordx2 s[24:25], s[0:1], 48
    s_load_dwordx2 s[28:29], s[0:1], 56
    s_load_dwordx2 s[32:33], s[0:1], 80
    s_load_dwordx2 s[36:37], s[0:1], 88
    s_cmp_eq_u32 s44, 1
    s_cbranch_scc1 k1_pathB
    s_add_u32 s100, s101, 0
    s_and_b32 s100, s100, 7
    s_add_u32 m0, s54, 0
    s_lshl_b32 s50, s100, 7
    s_add_u32 s50, s50, s52
    buffer_load_dwordx4 v8, s[4:7], s50 offen lds
    s_add_u32 m0, s54, 1024
    s_lshl_b32 s50, s100, 7
    s_add_u32 s50, s50, s53
    buffer_load_dwordx4 v9, s[4:7], s50 offen lds
    s_add_u32 m0, s57, 16384
    s_mul_i32 s50, s100, 196608
    s_add_u32 s50, s50, s55
    buffer_load_dwordx4 v10, s[8:11], s50 offen lds
    s_add_u32 m0, s51, 28672
    s_mul_i32 s50, s100, 229376
    s_add_u32 s50, s50, s58
    buffer_load_dwordx4 v11, s[20:23], s50 offen lds
    s_add_u32 m0, s51, 29696
    s_mul_i32 s50, s100, 229376
    s_add_u32 s50, s50, s58
    s_add_u32 s50, s50, 28672
    buffer_load_dwordx4 v11, s[20:23], s50 offen lds
    s_add_u32 s100, s101, 1
    s_and_b32 s100, s100, 7
    s_add_u32 m0, s54, 45056
    s_lshl_b32 s50, s100, 7
    s_add_u32 s50, s50, s52
    buffer_load_dwordx4 v8, s[4:7], s50 offen lds
    s_add_u32 m0, s54, 46080
    s_lshl_b32 s50, s100, 7
    s_add_u32 s50, s50, s53
    buffer_load_dwordx4 v9, s[4:7], s50 offen lds
    s_add_u32 m0, s57, 61440
    s_mul_i32 s50, s100, 196608
    s_add_u32 s50, s50, s55
    buffer_load_dwordx4 v10, s[8:11], s50 offen lds
    s_add_u32 m0, s51, 73728
    s_mul_i32 s50, s100, 229376
    s_add_u32 s50, s50, s58
    buffer_load_dwordx4 v11, s[20:23], s50 offen lds
    s_add_u32 m0, s51, 74752
    s_mul_i32 s50, s100, 229376
    s_add_u32 s50, s50, s58
    s_add_u32 s50, s50, 28672
    buffer_load_dwordx4 v11, s[20:23], s50 offen lds
    v_and_b32 v2, 31, v1
    v_lshrrev_b32 v3, 5, v1
    v_lshlrev_b32 v4, 4, v1
    s_lshl_b32 s49, s41, 2
    s_add_u32 s49, s49, s43
    s_mov_b32 s46, 0x3f803f80
    s_mov_b32 s47, 0x3fb8aa3b
    s_mov_b32 s48, 0xffff0000
    s_waitcnt lgkmcnt(0)
    s_mov_b32 s14, 16384
    s_mov_b32 s15, 0x20000
    s_mov_b32 s18, 524288
    s_mov_b32 s19, 0x20000
    s_mov_b32 s26, 3584
    s_mov_b32 s27, 0x20000
    s_mov_b32 s30, 1835008
    s_mov_b32 s31, 0x20000
    s_mov_b32 s34, 256
    s_mov_b32 s35, 0x20000
    s_mov_b32 s38, 15728640
    s_mov_b32 s39, 0x20000
    v_mov_b32 v16, 0
    v_mov_b32 v17, 0
    v_mov_b32 v18, 0
    v_mov_b32 v19, 0
    v_add_u32 v14, 135168, v4
    ds_write_b128 v14, v[16:19] offset:1024
    s_cmp_lg_u32 s43, 0
    s_cbranch_scc1 k1_noreset
    s_lshl_b32 s60, s42, 7
    s_lshl_b32 s61, s41, 2
    s_add_u32 s60, s60, s61
    s_add_u32 s60, s60, 15204352
    s_lshl_b32 s61, s41, 7
    s_lshl_b32 s62, s42, 2
    s_add_u32 s61, s61, s62
    s_add_u32 s61, s61, 15204352
    v_lshlrev_b32 v14, 12, v1
    v_add_u32 v14, s61, v14
    v_mov_b32 v15, s60
    v_cmp_eq_u32 vcc, 0, v1
    s_nop 1
    v_cndmask_b32 v14, v14, v15, vcc
    s_lshl_b32 s60, s2, 2
    s_add_u32 s60, s60, 15216640
    v_mov_b32 v15, s60
    v_cmp_eq_u32 vcc, 3, v1
    s_nop 1
    v_cndmask_b32 v14, v14, v15, vcc
    v_mov_b32 v15, 0
    s_mov_b64 exec, 15
    buffer_store_dword v15, v14, s[36:39], 0 offen sc1
    s_mov_b64 exec, -1
k1_noreset:
    s_lshl_b32 s60, s42, 10
    s_mov_b32 m0, 160768
    s_nop 0
    buffer_load_dwordx4 v4, s[12:15], s60 offen lds
    v_lshrrev_b32 v152, 2, v1
    v_and_b32 v153, 7, v152
    v_lshlrev_b32 v152, 10, v152
    v_lshlrev_b32 v153, 10, v153
    v_lshlrev_b32 v14, 14, v3
    v_add_u32 v153, v153, v14
    v_and_b32 v14, 3, v1
    v_lshlrev_b32 v14, 4, v14
    v_add_u32 v152, v152, v14
    v_add_u32 v153, v153, v14
    s_lshl_b32 s72, s43, 1
    s_and_b32 s62, s2, 15
    s_mul_i32 s62, s62, 9
    s_add_u32 s62, s62, s72
    s_lshr_b32 s63, s2, 4
    s_lshl_b32 s64, s62, 4
    s_sub_u32 s65, s62, 112
    s_lshr_b32 s66, s65, 1
    s_lshl_b32 s66, s66, 5
    s_and_b32 s65, s65, 1
    s_lshl_b32 s65, s65, 3
    s_add_u32 s65, s65, s66
    s_cmp_lt_u32 s62, 112
    s_cselect_b32 s64, s64, s65
    s_cselect_b32 s95, 1, 0
    s_cselect_b32 s68, s28, s16
    s_cselect_b32 s69, s29, s17
    s_cselect_b32 s70, s30, s18
    s_mov_b32 s71, 0x20000
    s_cselect_b64 vcc, -1, 0
    v_cndmask_b32 v14, v153, v152, vcc
    s_lshl_b32 s64, s64, 10
    s_lshl_b32 s65, s63, 6
    s_add_u32 s64, s64, s65
    s_lshl_b32 s65, s72, 10
    s_add_u32 m0, s65, 151552
    s_nop 0
    buffer_load_dwordx4 v14, s[68:71], s64 offen lds
    s_mul_i32 s94, s63, 144
    s_add_u32 s94, s94, s62
    s_lshl_b32 s94, s94, 10
    s_add_u32 s94, s94, 10485760
    s_add_u32 s72, s72, 1
    s_and_b32 s62, s2, 15
    s_mul_i32 s62, s62, 9
    s_add_u32 s62, s62, s72
    s_lshr_b32 s63, s2, 4
    s_lshl_b32 s64, s62, 4
    s_sub_u32 s65, s62, 112
    s_lshr_b32 s66, s65, 1
    s_lshl_b32 s66, s66, 5
    s_and_b32 s65, s65, 1
    s_lshl_b32 s65, s65, 3
    s_add_u32 s65, s65, s66
    s_cmp_lt_u32 s62, 112
    s_cselect_b32 s64, s64, s65
    s_cselect_b32 s97, 1, 0
    s_cselect_b32 s68, s28, s16
    s_cselect_b32 s69, s29, s17
    s_cselect_b32 s70, s30, s18
    s_mov_b32 s71, 0x20000
    s_cselect_b64 vcc, -1, 0
    v_cndmask_b32 v14, v153, v152, vcc
    s_lshl_b32 s64, s64, 10
    s_lshl_b32 s65, s63, 6
    s_add_u32 s64, s64, s65
    s_lshl_b32 s65, s72, 10
    s_add_u32 m0, s65, 151552
    s_nop 0
    buffer_load_dwordx4 v14, s[68:71], s64 offen lds
    s_mul_i32 s96, s63, 144
    s_add_u32 s96, s96, s62
    s_lshl_b32 s96, s96, 10
    s_add_u32 s96, s96, 10485760
    s_and_b32 s62, s2, 15
    s_mul_i32 s62, s62, 9
    s_add_u32 s62, s62, 8
    s_lshr_b32 s63, s2, 4
    s_lshl_b32 s64, s62, 4
    s_sub_u32 s65, s62, 112
    s_lshr_b32 s66, s65, 1
    s_lshl_b32 s66, s66, 5
    s_and_b32 s65, s65, 1
    s_lshl_b32 s65, s65, 3
    s_add_u32 s65, s65, s66
    s_cmp_lt_u32 s62, 112
    s_cselect_b32 s64, s64, s65
    s_cselect_b32 s99, 1, 0
    s_cselect_b32 s68, s28, s16
    s_cselect_b32 s69, s29, s17
    s_cselect_b32 s70, s30, s18
    s_mov_b32 s71, 0x20000
    s_cselect_b64 vcc, -1, 0
    v_cndmask_b32 v14, v153, v152, vcc
    s_lshl_b32 s64, s64, 10
    s_lshl_b32 s65, s63, 6
    s_add_u32 s64, s64, s65
    s_lshl_b32 s65, 8, 10
    s_add_u32 m0, s65, 151552
    s_nop 0
    buffer_load_dwordx4 v14, s[68:71], s64 offen lds
    s_mul_i32 s98, s63, 144
    s_add_u32 s98, s98, s62
    s_lshl_b32 s98, s98, 10
    s_add_u32 s98, s98, 10485760
    s_lshl_b32 s60, s43, 12
    v_lshlrev_b32 v6, 7, v2
    v_add_u32 v6, s60, v6
    v_lshrrev_b32 v7, 1, v2
    v_and_b32 v7, 7, v7
    v_add_u32 v16, 0, v3
    v_xor_b32 v16, v16, v7
    v_lshlrev_b32 v16, 4, v16
    v_add_u32 v16, v16, v6
    v_add_u32 v17, 2, v3
    v_xor_b32 v17, v17, v7
    v_lshlrev_b32 v17, 4, v17
    v_add_u32 v17, v17, v6
    v_add_u32 v18, 4, v3
    v_xor_b32 v18, v18, v7
    v_lshlrev_b32 v18, 4, v18
    v_add_u32 v18, v18, v6
    v_add_u32 v19, 6, v3
    v_xor_b32 v19, v19, v7
    v_lshlrev_b32 v19, 4, v19
    v_add_u32 v19, v19, v6
    v_lshlrev_b32 v20, 9, v3
    v_and_b32 v14, 15, v1
    v_lshrrev_b32 v15, 2, v14
    v_lshlrev_b32 v15, 6, v15
    v_add_u32 v20, v20, v15
    v_and_b32 v15, 3, v1
    v_lshlrev_b32 v15, 3, v15
    v_add_u32 v20, v20, v15
    v_and_b32 v15, 16, v1
    v_lshlrev_b32 v15, 1, v15
    v_add_u32 v20, v20, v15
    v_add_u32 v20, 16384, v20
    s_lshl_b32 s60, s43, 10
    v_add_u32 v21, s60, v20
    v_lshlrev_b32 v22, 10, v3
    v_and_b32 v14, 15, v1
    v_lshrrev_b32 v15, 2, v14
    v_lshlrev_b32 v15, 7, v15
    v_add_u32 v22, v22, v15
    v_and_b32 v15, 3, v1
    v_lshlrev_b32 v15, 3, v15
    v_add_u32 v22, v22, v15
    v_and_b32 v15, 16, v1
    v_lshlrev_b32 v15, 1, v15
    v_add_u32 v22, v22, v15
    v_and_b32 v15, 8, v1
    v_lshlrev_b32 v15, 3, v15
    v_add_u32 v22, v22, v15
    v_add_u32 v22, 28672, v22
    v_xor_b32 v23, 64, v22
    s_lshl_b32 s60, s43, 11
    v_add_u32 v24, s60, v22
    v_add_u32 v25, s60, v23
    v_add_u32 v26, 45056, v16
    v_add_u32 v27, 45056, v17
    v_add_u32 v28, 45056, v18
    v_add_u32 v29, 45056, v19
    v_add_u32 v30, 45056, v20
    v_add_u32 v31, 45056, v21
    v_add_u32 v32, 45056, v22
    v_add_u32 v33, 45056, v23
    v_add_u32 v34, 45056, v24
    v_add_u32 v35, 45056, v25
    v_add_u32 v36, 90112, v16
    v_add_u32 v37, 90112, v17
    v_add_u32 v38, 90112, v18
    v_add_u32 v39, 90112, v19
    v_add_u32 v40, 90112, v20
    v_add_u32 v41, 90112, v21
    v_add_u32 v42, 90112, v22
    v_add_u32 v43, 90112, v23
    v_add_u32 v44, 90112, v24
    v_add_u32 v45, 90112, v25
    v_and_b32 v14, 15, v1
    v_lshrrev_b32 v15, 4, v1
    v_and_b32 v15, 1, v15
    v_cmp_eq_u32 vcc, v14, v15
    v_mov_b32 v14, s46
    s_nop 0
    v_cndmask_b32 v46, 0, v14, vcc
    v_cndmask_b32 v47, 0, v14, vcc
    v_cndmask_b32 v48, 0, v14, vcc
    v_cndmask_b32 v49, 0, v14, vcc
    v_mov_b32 v6, 0
    v_mov_b32 v7, 0
    v_mov_b32 v54, 0
    v_mov_b32 v55, 0
    v_mov_b32 v160, 0
    v_mov_b32 v161, 0
    v_mov_b32 v162, 0
    v_mov_b32 v163, 0
    v_mov_b32 v164, 0
    v_mov_b32 v165, 0
    v_mov_b32 v166, 0
    v_mov_b32 v167, 0
    v_mov_b32 v168, 0
    v_mov_b32 v169, 0
    v_mov_b32 v170, 0
    v_mov_b32 v171, 0
    s_waitcnt vmcnt(9) lgkmcnt(0)
    s_barrier
    s_add_u32 s100, s101, 2
    s_and_b32 s100, s100, 7
    s_add_u32 m0, s54, 90112
    s_lshl_b32 s50, s100, 7
    s_add_u32 s50, s50, s52
    buffer_load_dwordx4 v8, s[4:7], s50 offen lds
    ds_read_b128 v[176:179], v16
    ds_read_b64_tr_b16 v[192:193], v20 offset:0
    ds_read_b64_tr_b16 v[194:195], v20 offset:256
    ds_read_b64_tr_b16 v[196:197], v22 offset:0
    ds_read_b64_tr_b16 v[198:199], v22 offset:512
    ds_read_b64_tr_b16 v[200:201], v23 offset:0
    ds_read_b64_tr_b16 v[202:203], v23 offset:512
    s_add_u32 m0, s54, 91136
    s_lshl_b32 s50, s100, 7
    s_add_u32 s50, s50, s53
    buffer_load_dwordx4 v9, s[4:7], s50 offen lds
    ds_read_b128 v[180:183], v17
    ds_read_b64_tr_b16 v[204:205], v20 offset:1024
    ds_read_b64_tr_b16 v[206:207], v20 offset:1280
    ds_read_b64_tr_b16 v[208:209], v22 offset:2048
    ds_read_b64_tr_b16 v[210:211], v22 offset:2560
    ds_read_b64_tr_b16 v[212:213], v23 offset:2048
    ds_read_b64_tr_b16 v[214:215], v23 offset:2560
    s_add_u32 m0, s57, 106496
    s_mul_i32 s50, s100, 196608
    s_add_u32 s50, s50, s55
    buffer_load_dwordx4 v10, s[8:11], s50 offen lds
    s_add_u32 m0, s51, 118784
    s_mul_i32 s50, s100, 229376
    s_add_u32 s50, s50, s58
    buffer_load_dwordx4 v11, s[20:23], s50 offen lds
    s_waitcnt lgkmcnt(11)
    v_mfma_f32_32x32x16_bf16 v[64:79], v[192:195], v[176:179], 0
    ds_read_b128 v[184:187], v18
    ds_read_b64_tr_b16 v[216:217], v20 offset:2048
    v_lshlrev_b32 v50, 16, v176
    v_and_b32 v51, s48, v176
    v_add_f32 v6, v6, v50
    v_fmac_f32 v54, v50, v50
    v_add_f32 v7, v7, v51
    v_fmac_f32 v55, v51, v51
    v_lshlrev_b32 v52, 16, v177
    v_and_b32 v53, s48, v177
    s_waitcnt lgkmcnt(11)
    v_mfma_f32_32x32x16_bf16 v[80:95], v[196:199], v[176:179], 0
    ds_read_b64_tr_b16 v[218:219], v20 offset:2304
    ds_read_b64_tr_b16 v[220:221], v22 offset:4096
    v_add_f32 v6, v6, v52
    v_fmac_f32 v54, v52, v52
    v_add_f32 v7, v7, v53
    v_fmac_f32 v55, v53, v53
    v_lshlrev_b32 v50, 16, v178
    v_and_b32 v51, s48, v178
    v_add_f32 v6, v6, v50
    v_fmac_f32 v54, v50, v50
    s_waitcnt lgkmcnt(11)
    v_mfma_f32_32x32x16_bf16 v[96:111], v[200:203], v[176:179], 0
    ds_read_b64_tr_b16 v[222:223], v22 offset:4608
    ds_read_b64_tr_b16 v[224:225], v23 offset:4096
    ds_read_b64_tr_b16 v[226:227], v23 offset:4608
    v_add_f32 v7, v7, v51
    v_fmac_f32 v55, v51, v51
    v_lshlrev_b32 v52, 16, v179
    v_and_b32 v53, s48, v179
    v_add_f32 v6, v6, v52
    v_fmac_f32 v54, v52, v52
    v_add_f32 v7, v7, v53
    v_fmac_f32 v55, v53, v53
    s_cmp_lg_u32 s43, 0
    s_cbranch_scc1 k1_csA0
    v_mfma_f32_16x16x32_bf16 v[160:163], v[192:195], v[46:49], v[160:163]
    v_mfma_f32_16x16x32_bf16 v[164:167], v[196:199], v[46:49], v[164:167]
    v_mfma_f32_16x16x32_bf16 v[168:171], v[200:203], v[46:49], v[168:171]
k1_csA0:
    s_add_u32 m0, s51, 119808
    s_mul_i32 s50, s100, 229376
    s_add_u32 s50, s50, s58
    s_add_u32 s50, s50, 28672
    buffer_load_dwordx4 v11, s[20:23], s50 offen lds
    s_waitcnt lgkmcnt(11)
    v_mfma_f32_32x32x16_bf16 v[64:79], v[204:207], v[180:183], v[64:79]
    ds_read_b128 v[188:191], v19
    ds_read_b64_tr_b16 v[228:229], v20 offset:3072
    s_waitcnt lgkmcnt(11)
    v_mfma_f32_32x32x16_bf16 v[80:95], v[208:211], v[180:183], v[80:95]
    ds_read_b64_tr_b16 v[230:231], v20 offset:3328
    ds_read_b64_tr_b16 v[232:233], v22 offset:6144
    s_waitcnt lgkmcnt(11)
    v_mfma_f32_32x32x16_bf16 v[96:111], v[212:215], v[180:183], v[96:111]
    ds_read_b64_tr_b16 v[234:235], v22 offset:6656
    ds_read_b64_tr_b16 v[236:237], v23 offset:6144
    ds_read_b64_tr_b16 v[238:239], v23 offset:6656
    s_cmp_lg_u32 s43, 1
    s_cbranch_scc1 k1_csA1
    v_mfma_f32_16x16x32_bf16 v[160:163], v[204:207], v[46:49], v[160:163]
    v_mfma_f32_16x16x32_bf16 v[164:167], v[208:211], v[46:49], v[164:167]
    v_mfma_f32_16x16x32_bf16 v[168:171], v[212:215], v[46:49], v[168:171]
k1_csA1:
    s_waitcnt vmcnt(9) lgkmcnt(0)
    s_barrier
    s_add_u32 s100, s101, 3
    s_and_b32 s100, s100, 7
    s_add_u32 m0, s54, 0
    s_lshl_b32 s50, s100, 7
    s_add_u32 s50, s50, s52
    buffer_load_dwordx4 v8, s[4:7], s50 offen lds
    v_mfma_f32_32x32x16_bf16 v[64:79], v[216:219], v[184:187], v[64:79]
    ds_read_b128 v[176:179], v26
    ds_read_b64_tr_b16 v[192:193], v30 offset:0
    v_lshlrev_b32 v50, 16, v184
    v_and_b32 v51, s48, v184
    v_add_f32 v6, v6, v50
    v_fmac_f32 v54, v50, v50
    v_add_f32 v7, v7, v51
    v_fmac_f32 v55, v51, v51
    v_lshlrev_b32 v52, 16, v185
    v_and_b32 v53, s48, v185
    v_mfma_f32_32x32x16_bf16 v[80:95], v[220:223], v[184:187], v[80:95]
    ds_read_b64_tr_b16 v[194:195], v30 offset:256
    ds_read_b64_tr_b16 v[196:197], v32 offset:0
    v_add_f32 v6, v6, v52
    v_fmac_f32 v54, v52, v52
    v_add_f32 v7, v7, v53
    v_fmac_f32 v55, v53, v53
    v_lshlrev_b32 v50, 16, v186
    v_and_b32 v51, s48, v186
    v_add_f32 v6, v6, v50
    v_fmac_f32 v54, v50, v50
    v_mfma_f32_32x32x16_bf16 v[96:111], v[224:227], v[184:187], v[96:111]
    ds_read_b64_tr_b16 v[198:199], v32 offset:512
    ds_read_b64_tr_b16 v[200:201], v33 offset:0
    ds_read_b64_tr_b16 v[202:203], v33 offset:512
    v_add_f32 v7, v7, v51
    v_fmac_f32 v55, v51, v51
    v_lshlrev_b32 v52, 16, v187
    v_and_b32 v53, s48, v187
    v_add_f32 v6, v6, v52
    v_fmac_f32 v54, v52, v52
    v_add_f32 v7, v7, v53
    v_fmac_f32 v55, v53, v53
    s_cmp_lg_u32 s43, 2
    s_cbranch_scc1 k1_csA2
    v_mfma_f32_16x16x32_bf16 v[160:163], v[216:219], v[46:49], v[160:163]
    v_mfma_f32_16x16x32_bf16 v[164:167], v[220:223], v[46:49], v[164:167]
    v_mfma_f32_16x16x32_bf16 v[168:171], v[224:227], v[46:49], v[168:171]
k1_csA2:
    s_add_u32 m0, s54, 1024
    s_lshl_b32 s50, s100, 7
    s_add_u32 s50, s50, s53
    buffer_load_dwordx4 v9, s[4:7], s50 offen lds
    v_mfma_f32_32x32x16_bf16 v[64:79], v[228:231], v[188:191], v[64:79]
    ds_read_b128 v[180:183], v27
    ds_read_b64_tr_b16 v[204:205], v30 offset:1024
    v_mfma_f32_32x32x16_bf16 v[80:95], v[232:235], v[188:191], v[80:95]
    ds_read_b64_tr_b16 v[206:207], v30 offset:1280
    ds_read_b64_tr_b16 v[208:209], v32 offset:2048
    v_mfma_f32_32x32x16_bf16 v[96:111], v[236:239], v[188:191], v[96:111]
    ds_read_b64_tr_b16 v[210:211], v32 offset:2560
    ds_read_b64_tr_b16 v[212:213], v33 offset:2048
    ds_read_b64_tr_b16 v[214:215], v33 offset:2560
    s_cmp_lg_u32 s43, 3
    s_cbranch_scc1 k1_csA3
    v_mfma_f32_16x16x32_bf16 v[160:163], v[228:231], v[46:49], v[160:163]
    v_mfma_f32_16x16x32_bf16 v[164:167], v[232:235], v[46:49], v[164:167]
    v_mfma_f32_16x16x32_bf16 v[168:171], v[236:239], v[46:49], v[168:171]
k1_csA3:
    s_add_u32 m0, s57, 16384
    s_mul_i32 s50, s100, 196608
    s_add_u32 s50, s50, s55
    buffer_load_dwordx4 v10, s[8:11], s50 offen lds
    s_add_u32 m0, s51, 28672
    s_mul_i32 s50, s100, 229376
    s_add_u32 s50, s50, s58
    buffer_load_dwordx4 v11, s[20:23], s50 offen lds
    s_waitcnt lgkmcnt(11)
    v_mfma_f32_32x32x16_bf16 v[64:79], v[192:195], v[176:179], v[64:79]
    ds_read_b128 v[184:187], v28
    ds_read_b64_tr_b16 v[216:217], v30 offset:2048
    v_lshlrev_b32 v50, 16, v176
    v_and_b32 v51, s48, v176
    v_add_f32 v6, v6, v50
    v_fmac_f32 v54, v50, v50
    v_add_f32 v7, v7, v51
    v_fmac_f32 v55, v51, v51
    v_lshlrev_b32 v52, 16, v177
    v_and_b32 v53, s48, v177
    s_waitcnt lgkmcnt(11)
    v_mfma_f32_32x32x16_bf16 v[80:95], v[196:199], v[176:179], v[80:95]
    ds_read_b64_tr_b16 v[218:219], v30 offset:2304
    ds_read_b64_tr_b16 v[220:221], v32 offset:4096
    v_add_f32 v6, v6, v52
    v_fmac_f32 v54, v52, v52
    v_add_f32 v7, v7, v53
    v_fmac_f32 v55, v53, v53
    v_lshlrev_b32 v50, 16, v178
    v_and_b32 v51, s48, v178
    v_add_f32 v6, v6, v50
    v_fmac_f32 v54, v50, v50
    s_waitcnt lgkmcnt(11)
    v_mfma_f32_32x32x16_bf16 v[96:111], v[200:203], v[176:179], v[96:111]
    ds_read_b64_tr_b16 v[222:223], v32 offset:4608
    ds_read_b64_tr_b16 v[224:225], v33 offset:4096
    ds_read_b64_tr_b16 v[226:227], v33 offset:4608
    v_add_f32 v7, v7, v51
    v_fmac_f32 v55, v51, v51
    v_lshlrev_b32 v52, 16, v179
    v_and_b32 v53, s48, v179
    v_add_f32 v6, v6, v52
    v_fmac_f32 v54, v52, v52
    v_add_f32 v7, v7, v53
    v_fmac_f32 v55, v53, v53
    s_cmp_lg_u32 s43, 0
    s_cbranch_scc1 k1_csA4
    v_mfma_f32_16x16x32_bf16 v[160:163], v[192:195], v[46:49], v[160:163]
    v_mfma_f32_16x16x32_bf16 v[164:167], v[196:199], v[46:49], v[164:167]
    v_mfma_f32_16x16x32_bf16 v[168:171], v[200:203], v[46:49], v[168:171]
k1_csA4:
    s_add_u32 m0, s51, 29696
    s_mul_i32 s50, s100, 229376
    s_add_u32 s50, s50, s58
    s_add_u32 s50, s50, 28672
    buffer_load_dwordx4 v11, s[20:23], s50 offen lds
    s_waitcnt lgkmcnt(11)
    v_mfma_f32_32x32x16_bf16 v[64:79], v[204:207], v[180:183], v[64:79]
    ds_read_b128 v[188:191], v29
    ds_read_b64_tr_b16 v[228:229], v30 offset:3072
    s_waitcnt lgkmcnt(11)
    v_mfma_f32_32x32x16_bf16 v[80:95], v[208:211], v[180:183], v[80:95]
    ds_read_b64_tr_b16 v[230:231], v30 offset:3328
    ds_read_b64_tr_b16 v[232:233], v32 offset:6144
    s_waitcnt lgkmcnt(11)
    v_mfma_f32_32x32x16_bf16 v[96:111], v[212:215], v[180:183], v[96:111]
    ds_read_b64_tr_b16 v[234:235], v32 offset:6656
    ds_read_b64_tr_b16 v[236:237], v33 offset:6144
    ds_read_b64_tr_b16 v[238:239], v33 offset:6656
    s_cmp_lg_u32 s43, 1
    s_cbranch_scc1 k1_csA5
    v_mfma_f32_16x16x32_bf16 v[160:163], v[204:207], v[46:49], v[160:163]
    v_mfma_f32_16x16x32_bf16 v[164:167], v[208:211], v[46:49], v[164:167]
    v_mfma_f32_16x16x32_bf16 v[168:171], v[212:215], v[46:49], v[168:171]
k1_csA5:
    s_waitcnt vmcnt(5) lgkmcnt(0)
    s_barrier
    s_add_u32 s100, s101, 4
    s_and_b32 s100, s100, 7
    s_add_u32 m0, s54, 45056
    s_lshl_b32 s50, s100, 7
    s_add_u32 s50, s50, s52
    buffer_load_dwordx4 v8, s[4:7], s50 offen lds
    v_mfma_f32_32x32x16_bf16 v[64:79], v[216:219], v[184:187], v[64:79]
    ds_read_b128 v[176:179], v36
    ds_read_b64_tr_b16 v[192:193], v40 offset:0
    v_lshlrev_b32 v50, 16, v184
    v_and_b32 v51, s48, v184
    v_add_f32 v6, v6, v50
    v_fmac_f32 v54, v50, v50
    v_add_f32 v7, v7, v51
    v_fmac_f32 v55, v51, v51
    v_lshlrev_b32 v52, 16, v185
    v_and_b32 v53, s48, v185
    v_mfma_f32_32x32x16_bf16 v[80:95], v[220:223], v[184:187], v[80:95]
    ds_read_b64_tr_b16 v[194:195], v40 offset:256
    ds_read_b64_tr_b16 v[196:197], v42 offset:0
    v_add_f32 v6, v6, v52
    v_fmac_f32 v54, v52, v52
    v_add_f32 v7, v7, v53
    v_fmac_f32 v55, v53, v53
    v_lshlrev_b32 v50, 16, v186
    v_and_b32 v51, s48, v186
    v_add_f32 v6, v6, v50
    v_fmac_f32 v54, v50, v50
    v_mfma_f32_32x32x16_bf16 v[96:111], v[224:227], v[184:187], v[96:111]
    ds_read_b64_tr_b16 v[198:199], v42 offset:512
    ds_read_b64_tr_b16 v[200:201], v43 offset:0
    ds_read_b64_tr_b16 v[202:203], v43 offset:512
    v_add_f32 v7, v7, v51
    v_fmac_f32 v55, v51, v51
    v_lshlrev_b32 v52, 16, v187
    v_and_b32 v53, s48, v187
    v_add_f32 v6, v6, v52
    v_fmac_f32 v54, v52, v52
    v_add_f32 v7, v7, v53
    v_fmac_f32 v55, v53, v53
    s_cmp_lg_u32 s43, 2
    s_cbranch_scc1 k1_csA6
    v_mfma_f32_16x16x32_bf16 v[160:163], v[216:219], v[46:49], v[160:163]
    v_mfma_f32_16x16x32_bf16 v[164:167], v[220:223], v[46:49], v[164:167]
    v_mfma_f32_16x16x32_bf16 v[168:171], v[224:227], v[46:49], v[168:171]
k1_csA6:
    s_add_u32 m0, s54, 46080
    s_lshl_b32 s50, s100, 7
    s_add_u32 s50, s50, s53
    buffer_load_dwordx4 v9, s[4:7], s50 offen lds
    v_mfma_f32_32x32x16_bf16 v[64:79], v[228:231], v[188:191], v[64:79]
    ds_read_b128 v[180:183], v37
    ds_read_b64_tr_b16 v[204:205], v40 offset:1024
    v_mfma_f32_32x32x16_bf16 v[80:95], v[232:235], v[188:191], v[80:95]
    ds_read_b64_tr_b16 v[206:207], v40 offset:1280
    ds_read_b64_tr_b16 v[208:209], v42 offset:2048
    v_mfma_f32_32x32x16_bf16 v[96:111], v[236:239], v[188:191], v[96:111]
    ds_read_b64_tr_b16 v[210:211], v42 offset:2560
    ds_read_b64_tr_b16 v[212:213], v43 offset:2048
    ds_read_b64_tr_b16 v[214:215], v43 offset:2560
    s_cmp_lg_u32 s43, 3
    s_cbranch_scc1 k1_csA7
    v_mfma_f32_16x16x32_bf16 v[160:163], v[228:231], v[46:49], v[160:163]
    v_mfma_f32_16x16x32_bf16 v[164:167], v[232:235], v[46:49], v[164:167]
    v_mfma_f32_16x16x32_bf16 v[168:171], v[236:239], v[46:49], v[168:171]
k1_csA7:
    s_add_u32 m0, s57, 61440
    s_mul_i32 s50, s100, 196608
    s_add_u32 s50, s50, s55
    buffer_load_dwordx4 v10, s[8:11], s50 offen lds
    s_add_u32 m0, s51, 73728
    s_mul_i32 s50, s100, 229376
    s_add_u32 s50, s50, s58
    buffer_load_dwordx4 v11, s[20:23], s50 offen lds
    s_waitcnt lgkmcnt(11)
    v_mfma_f32_32x32x16_bf16 v[64:79], v[192:195], v[176:179], v[64:79]
    ds_read_b128 v[184:187], v38
    ds_read_b64_tr_b16 v[216:217], v40 offset:2048
    v_lshlrev_b32 v50, 16, v176
    v_and_b32 v51, s48, v176
    v_add_f32 v6, v6, v50
    v_fmac_f32 v54, v50, v50
    v_add_f32 v7, v7, v51
    v_fmac_f32 v55, v51, v51
    v_lshlrev_b32 v52, 16, v177
    v_and_b32 v53, s48, v177
    s_waitcnt lgkmcnt(11)
    v_mfma_f32_32x32x16_bf16 v[80:95], v[196:199], v[176:179], v[80:95]
    ds_read_b64_tr_b16 v[218:219], v40 offset:2304
    ds_read_b64_tr_b16 v[220:221], v42 offset:4096
    v_add_f32 v6, v6, v52
    v_fmac_f32 v54, v52, v52
    v_add_f32 v7, v7, v53
    v_fmac_f32 v55, v53, v53
    v_lshlrev_b32 v50, 16, v178
    v_and_b32 v51, s48, v178
    v_add_f32 v6, v6, v50
    v_fmac_f32 v54, v50, v50
    s_waitcnt lgkmcnt(11)
    v_mfma_f32_32x32x16_bf16 v[96:111], v[200:203], v[176:179], v[96:111]
    ds_read_b64_tr_b16 v[222:223], v42 offset:4608
    ds_read_b64_tr_b16 v[224:225], v43 offset:4096
    ds_read_b64_tr_b16 v[226:227], v43 offset:4608
    v_add_f32 v7, v7, v51
    v_fmac_f32 v55, v51, v51
    v_lshlrev_b32 v52, 16, v179
    v_and_b32 v53, s48, v179
    v_add_f32 v6, v6, v52
    v_fmac_f32 v54, v52, v52
    v_add_f32 v7, v7, v53
    v_fmac_f32 v55, v53, v53
    s_cmp_lg_u32 s43, 0
    s_cbranch_scc1 k1_csA8
    v_mfma_f32_16x16x32_bf16 v[160:163], v[192:195], v[46:49], v[160:163]
    v_mfma_f32_16x16x32_bf16 v[164:167], v[196:199], v[46:49], v[164:167]
    v_mfma_f32_16x16x32_bf16 v[168:171], v[200:203], v[46:49], v[168:171]
k1_csA8:
    s_add_u32 m0, s51, 74752
    s_mul_i32 s50, s100, 229376
    s_add_u32 s50, s50, s58
    s_add_u32 s50, s50, 28672
    buffer_load_dwordx4 v11, s[20:23], s50 offen lds
    s_lshr_b32 s61, s2, 3
    s_and_b32 s61, s61, 3
    s_lshl_b32 s61, s61, 2
    s_add_u32 s61, s61, s43
    s_cmp_lg_u32 s61, 0
    s_cbranch_scc1 k1_nocount0
    s_lshl_b32 s61, s42, 4
    v_mov_b32 v14, s61
    v_mov_b32 v15, 1
    s_mov_b64 exec, 1
    buffer_atomic_add v15, v14, s[32:35], 0 offen sc1
    s_mov_b64 exec, -1
k1_nocount0:
    s_waitcnt lgkmcnt(11)
    v_mfma_f32_32x32x16_bf16 v[64:79], v[204:207], v[180:183], v[64:79]
    ds_read_b128 v[188:191], v39
    ds_read_b64_tr_b16 v[228:229], v40 offset:3072
    s_waitcnt lgkmcnt(11)
    v_mfma_f32_32x32x16_bf16 v[80:95], v[208:211], v[180:183], v[80:95]
    ds_read_b64_tr_b16 v[230:231], v40 offset:3328
    ds_read_b64_tr_b16 v[232:233], v42 offset:6144
    s_waitcnt lgkmcnt(11)
    v_mfma_f32_32x32x16_bf16 v[96:111], v[212:215], v[180:183], v[96:111]
    ds_read_b64_tr_b16 v[234:235], v42 offset:6656
    ds_read_b64_tr_b16 v[236:237], v43 offset:6144
    ds_read_b64_tr_b16 v[238:239], v43 offset:6656
    s_cmp_lg_u32 s43, 1
    s_cbranch_scc1 k1_csA9
    v_mfma_f32_16x16x32_bf16 v[160:163], v[204:207], v[46:49], v[160:163]
    v_mfma_f32_16x16x32_bf16 v[164:167], v[208:211], v[46:49], v[164:167]
    v_mfma_f32_16x16x32_bf16 v[168:171], v[212:215], v[46:49], v[168:171]
k1_csA9:
    s_waitcnt vmcnt(5) lgkmcnt(0)
    s_barrier
    s_add_u32 s100, s101, 5
    s_and_b32 s100, s100, 7
    s_add_u32 m0, s54, 90112
    s_lshl_b32 s50, s100, 7
    s_add_u32 s50, s50, s52
    buffer_load_dwordx4 v8, s[4:7], s50 offen lds
    v_mfma_f32_32x32x16_bf16 v[64:79], v[216:219], v[184:187], v[64:79]
    ds_read_b128 v[176:179], v16
    ds_read_b64_tr_b16 v[192:193], v20 offset:0
    v_lshlrev_b32 v50, 16, v184
    v_and_b32 v51, s48, v184
    v_add_f32 v6, v6, v50
    v_fmac_f32 v54, v50, v50
    v_add_f32 v7, v7, v51
    v_fmac_f32 v55, v51, v51
    v_lshlrev_b32 v52, 16, v185
    v_and_b32 v53, s48, v185
    v_mfma_f32_32x32x16_bf16 v[80:95], v[220:223], v[184:187], v[80:95]
    ds_read_b64_tr_b16 v[194:195], v20 offset:256
    ds_read_b64_tr_b16 v[196:197], v22 offset:0
    v_add_f32 v6, v6, v52
    v_fmac_f32 v54, v52, v52
    v_add_f32 v7, v7, v53
    v_fmac_f32 v55, v53, v53
    v_lshlrev_b32 v50, 16, v186
    v_and_b32 v51, s48, v186
    v_add_f32 v6, v6, v50
    v_fmac_f32 v54, v50, v50
    v_mfma_f32_32x32x16_bf16 v[96:111], v[224:227], v[184:187], v[96:111]
    ds_read_b64_tr_b16 v[198:199], v22 offset:512
    ds_read_b64_tr_b16 v[200:201], v23 offset:0
    ds_read_b64_tr_b16 v[202:203], v23 offset:512
    v_add_f32 v7, v7, v51
    v_fmac_f32 v55, v51, v51
    v_lshlrev_b32 v52, 16, v187
    v_and_b32 v53, s48, v187
    v_add_f32 v6, v6, v52
    v_fmac_f32 v54, v52, v52
    v_add_f32 v7, v7, v53
    v_fmac_f32 v55, v53, v53
    s_cmp_lg_u32 s43, 2
    s_cbranch_scc1 k1_csA10
    v_mfma_f32_16x16x32_bf16 v[160:163], v[216:219], v[46:49], v[160:163]
    v_mfma_f32_16x16x32_bf16 v[164:167], v[220:223], v[46:49], v[164:167]
    v_mfma_f32_16x16x32_bf16 v[168:171], v[224:227], v[46:49], v[168:171]
k1_csA10:
    s_add_u32 m0, s54, 91136
    s_lshl_b32 s50, s100, 7
    s_add_u32 s50, s50, s53
    buffer_load_dwordx4 v9, s[4:7], s50 offen lds
    v_mfma_f32_32x32x16_bf16 v[64:79], v[228:231], v[188:191], v[64:79]
    ds_read_b128 v[180:183], v17
    ds_read_b64_tr_b16 v[204:205], v20 offset:1024
    v_mfma_f32_32x32x16_bf16 v[80:95], v[232:235], v[188:191], v[80:95]
    ds_read_b64_tr_b16 v[206:207], v20 offset:1280
    ds_read_b64_tr_b16 v[208:209], v22 offset:2048
    v_mfma_f32_32x32x16_bf16 v[96:111], v[236:239], v[188:191], v[96:111]
    ds_read_b64_tr_b16 v[210:211], v22 offset:2560
    ds_read_b64_tr_b16 v[212:213], v23 offset:2048
    ds_read_b64_tr_b16 v[214:215], v23 offset:2560
    s_cmp_lg_u32 s43, 3
    s_cbranch_scc1 k1_csA11
    v_mfma_f32_16x16x32_bf16 v[160:163], v[228:231], v[46:49], v[160:163]
    v_mfma_f32_16x16x32_bf16 v[164:167], v[232:235], v[46:49], v[164:167]
    v_mfma_f32_16x16x32_bf16 v[168:171], v[236:239], v[46:49], v[168:171]
k1_csA11:
    s_add_u32 m0, s57, 106496
    s_mul_i32 s50, s100, 196608
    s_add_u32 s50, s50, s55
    buffer_load_dwordx4 v10, s[8:11], s50 offen lds
    s_add_u32 m0, s51, 118784
    s_mul_i32 s50, s100, 229376
    s_add_u32 s50, s50, s58
    buffer_load_dwordx4 v11, s[20:23], s50 offen lds
    s_waitcnt lgkmcnt(11)
    v_mfma_f32_32x32x16_bf16 v[64:79], v[192:195], v[176:179], v[64:79]
    ds_read_b128 v[184:187], v18
    ds_read_b64_tr_b16 v[216:217], v20 offset:2048
    v_lshlrev_b32 v50, 16, v176
    v_and_b32 v51, s48, v176
    v_add_f32 v6, v6, v50
    v_fmac_f32 v54, v50, v50
    v_add_f32 v7, v7, v51
    v_fmac_f32 v55, v51, v51
    v_lshlrev_b32 v52, 16, v177
    v_and_b32 v53, s48, v177
    s_waitcnt lgkmcnt(11)
    v_mfma_f32_32x32x16_bf16 v[80:95], v[196:199], v[176:179], v[80:95]
    ds_read_b64_tr_b16 v[218:219], v20 offset:2304
    ds_read_b64_tr_b16 v[220:221], v22 offset:4096
    v_add_f32 v6, v6, v52
    v_fmac_f32 v54, v52, v52
    v_add_f32 v7, v7, v53
    v_fmac_f32 v55, v53, v53
    v_lshlrev_b32 v50, 16, v178
    v_and_b32 v51, s48, v178
    v_add_f32 v6, v6, v50
    v_fmac_f32 v54, v50, v50
    s_waitcnt lgkmcnt(11)
    v_mfma_f32_32x32x16_bf16 v[96:111], v[200:203], v[176:179], v[96:111]
    ds_read_b64_tr_b16 v[222:223], v22 offset:4608
    ds_read_b64_tr_b16 v[224:225], v23 offset:4096
    ds_read_b64_tr_b16 v[226:227], v23 offset:4608
    v_add_f32 v7, v7, v51
    v_fmac_f32 v55, v51, v51
    v_lshlrev_b32 v52, 16, v179
    v_and_b32 v53, s48, v179
    v_add_f32 v6, v6, v52
    v_fmac_f32 v54, v52, v52
    v_add_f32 v7, v7, v53
    v_fmac_f32 v55, v53, v53
    s_cmp_lg_u32 s43, 0
    s_cbranch_scc1 k1_csA12
    v_mfma_f32_16x16x32_bf16 v[160:163], v[192:195], v[46:49], v[160:163]
    v_mfma_f32_16x16x32_bf16 v[164:167], v[196:199], v[46:49], v[164:167]
    v_mfma_f32_16x16x32_bf16 v[168:171], v[200:203], v[46:49], v[168:171]
k1_csA12:
    s_add_u32 m0, s51, 119808
    s_mul_i32 s50, s100, 229376
    s_add_u32 s50, s50, s58
    s_add_u32 s50, s50, 28672
    buffer_load_dwordx4 v11, s[20:23], s50 offen lds
    s_lshr_b32 s61, s2, 3
    s_and_b32 s61, s61, 3
    s_lshl_b32 s61, s61, 2
    s_add_u32 s61, s61, s43
    s_cmp_lg_u32 s61, 4
    s_cbranch_scc1 k1_nocount1
    s_lshl_b32 s61, s42, 4
    v_mov_b32 v14, s61
    v_mov_b32 v15, 1
    s_mov_b64 exec, 1
    buffer_atomic_add v15, v14, s[32:35], 0 offen sc1
    s_mov_b64 exec, -1
k1_nocount1:
    s_waitcnt lgkmcnt(11)
    v_mfma_f32_32x32x16_bf16 v[64:79], v[204:207], v[180:183], v[64:79]
    ds_read_b128 v[188:191], v19
    ds_read_b64_tr_b16 v[228:229], v20 offset:3072
    s_waitcnt lgkmcnt(11)
    v_mfma_f32_32x32x16_bf16 v[80:95], v[208:211], v[180:183], v[80:95]
    ds_read_b64_tr_b16 v[230:231], v20 offset:3328
    ds_read_b64_tr_b16 v[232:233], v22 offset:6144
    s_waitcnt lgkmcnt(11)
    v_mfma_f32_32x32x16_bf16 v[96:111], v[212:215], v[180:183], v[96:111]
    ds_read_b64_tr_b16 v[234:235], v22 offset:6656
    ds_read_b64_tr_b16 v[236:237], v23 offset:6144
    ds_read_b64_tr_b16 v[238:239], v23 offset:6656
    s_cmp_lg_u32 s43, 1
    s_cbranch_scc1 k1_csA13
    v_mfma_f32_16x16x32_bf16 v[160:163], v[204:207], v[46:49], v[160:163]
    v_mfma_f32_16x16x32_bf16 v[164:167], v[208:211], v[46:49], v[164:167]
    v_mfma_f32_16x16x32_bf16 v[168:171], v[212:215], v[46:49], v[168:171]
k1_csA13:
    s_waitcnt vmcnt(5) lgkmcnt(0)
    s_barrier
    s_add_u32 s100, s101, 6
    s_and_b32 s100, s100, 7
    s_add_u32 m0, s54, 0
    s_lshl_b32 s50, s100, 7
    s_add_u32 s50, s50, s52
    buffer_load_dwordx4 v8, s[4:7], s50 offen lds
    v_mfma_f32_32x32x16_bf16 v[64:79], v[216:219], v[184:187], v[64:79]
    ds_read_b128 v[176:179], v26
    ds_read_b64_tr_b16 v[192:193], v30 offset:0
    v_lshlrev_b32 v50, 16, v184
    v_and_b32 v51, s48, v184
    v_add_f32 v6, v6, v50
    v_fmac_f32 v54, v50, v50
    v_add_f32 v7, v7, v51
    v_fmac_f32 v55, v51, v51
    v_lshlrev_b32 v52, 16, v185
    v_and_b32 v53, s48, v185
    v_mfma_f32_32x32x16_bf16 v[80:95], v[220:223], v[184:187], v[80:95]
    ds_read_b64_tr_b16 v[194:195], v30 offset:256
    ds_read_b64_tr_b16 v[196:197], v32 offset:0
    v_add_f32 v6, v6, v52
    v_fmac_f32 v54, v52, v52
    v_add_f32 v7, v7, v53
    v_fmac_f32 v55, v53, v53
    v_lshlrev_b32 v50, 16, v186
    v_and_b32 v51, s48, v186
    v_add_f32 v6, v6, v50
    v_fmac_f32 v54, v50, v50
    v_mfma_f32_32x32x16_bf16 v[96:111], v[224:227], v[184:187], v[96:111]
    ds_read_b64_tr_b16 v[198:199], v32 offset:512
    ds_read_b64_tr_b16 v[200:201], v33 offset:0
    ds_read_b64_tr_b16 v[202:203], v33 offset:512
    v_add_f32 v7, v7, v51
    v_fmac_f32 v55, v51, v51
    v_lshlrev_b32 v52, 16, v187
    v_and_b32 v53, s48, v187
    v_add_f32 v6, v6, v52
    v_fmac_f32 v54, v52, v52
    v_add_f32 v7, v7, v53
    v_fmac_f32 v55, v53, v53
    s_cmp_lg_u32 s43, 2
    s_cbranch_scc1 k1_csA14
    v_mfma_f32_16x16x32_bf16 v[160:163], v[216:219], v[46:49], v[160:163]
    v_mfma_f32_16x16x32_bf16 v[164:167], v[220:223], v[46:49], v[164:167]
    v_mfma_f32_16x16x32_bf16 v[168:171], v[224:227], v[46:49], v[168:171]
k1_csA14:
    s_add_u32 m0, s54, 1024
    s_lshl_b32 s50, s100, 7
    s_add_u32 s50, s50, s53
    buffer_load_dwordx4 v9, s[4:7], s50 offen lds
    v_mfma_f32_32x32x16_bf16 v[64:79], v[228:231], v[188:191], v[64:79]
    ds_read_b128 v[180:183], v27
    ds_read_b64_tr_b16 v[204:205], v30 offset:1024
    v_mfma_f32_32x32x16_bf16 v[80:95], v[232:235], v[188:191], v[80:95]
    ds_read_b64_tr_b16 v[206:207], v30 offset:1280
    ds_read_b64_tr_b16 v[208:209], v32 offset:2048
    v_mfma_f32_32x32x16_bf16 v[96:111], v[236:239], v[188:191], v[96:111]
    ds_read_b64_tr_b16 v[210:211], v32 offset:2560
    ds_read_b64_tr_b16 v[212:213], v33 offset:2048
    ds_read_b64_tr_b16 v[214:215], v33 offset:2560
    s_cmp_lg_u32 s43, 3
    s_cbranch_scc1 k1_csA15
    v_mfma_f32_16x16x32_bf16 v[160:163], v[228:231], v[46:49], v[160:163]
    v_mfma_f32_16x16x32_bf16 v[164:167], v[232:235], v[46:49], v[164:167]
    v_mfma_f32_16x16x32_bf16 v[168:171], v[236:239], v[46:49], v[168:171]
k1_csA15:
    s_add_u32 m0, s57, 16384
    s_mul_i32 s50, s100, 196608
    s_add_u32 s50, s50, s55
    buffer_load_dwordx4 v10, s[8:11], s50 offen lds
    s_add_u32 m0, s51, 28672
    s_mul_i32 s50, s100, 229376
    s_add_u32 s50, s50, s58
    buffer_load_dwordx4 v11, s[20:23], s50 offen lds
    s_waitcnt lgkmcnt(11)
    v_mfma_f32_32x32x16_bf16 v[64:79], v[192:195], v[176:179], v[64:79]
    ds_read_b128 v[184:187], v28
    ds_read_b64_tr_b16 v[216:217], v30 offset:2048
    v_lshlrev_b32 v50, 16, v176
    v_and_b32 v51, s48, v176
    v_add_f32 v6, v6, v50
    v_fmac_f32 v54, v50, v50
    v_add_f32 v7, v7, v51
    v_fmac_f32 v55, v51, v51
    v_lshlrev_b32 v52, 16, v177
    v_and_b32 v53, s48, v177
    s_waitcnt lgkmcnt(11)
    v_mfma_f32_32x32x16_bf16 v[80:95], v[196:199], v[176:179], v[80:95]
    ds_read_b64_tr_b16 v[218:219], v30 offset:2304
    ds_read_b64_tr_b16 v[220:221], v32 offset:4096
    v_add_f32 v6, v6, v52
    v_fmac_f32 v54, v52, v52
    v_add_f32 v7, v7, v53
    v_fmac_f32 v55, v53, v53
    v_lshlrev_b32 v50, 16, v178
    v_and_b32 v51, s48, v178
    v_add_f32 v6, v6, v50
    v_fmac_f32 v54, v50, v50
    s_waitcnt lgkmcnt(11)
    v_mfma_f32_32x32x16_bf16 v[96:111], v[200:203], v[176:179], v[96:111]
    ds_read_b64_tr_b16 v[222:223], v32 offset:4608
    ds_read_b64_tr_b16 v[224:225], v33 offset:4096
    ds_read_b64_tr_b16 v[226:227], v33 offset:4608
    v_add_f32 v7, v7, v51
    v_fmac_f32 v55, v51, v51
    v_lshlrev_b32 v52, 16, v179
    v_and_b32 v53, s48, v179
    v_add_f32 v6, v6, v52
    v_fmac_f32 v54, v52, v52
    v_add_f32 v7, v7, v53
    v_fmac_f32 v55, v53, v53
    s_cmp_lg_u32 s43, 0
    s_cbranch_scc1 k1_csA16
    v_mfma_f32_16x16x32_bf16 v[160:163], v[192:195], v[46:49], v[160:163]
    v_mfma_f32_16x16x32_bf16 v[164:167], v[196:199], v[46:49], v[164:167]
    v_mfma_f32_16x16x32_bf16 v[168:171], v[200:203], v[46:49], v[168:171]
k1_csA16:
    s_add_u32 m0, s51, 29696
    s_mul_i32 s50, s100, 229376
    s_add_u32 s50, s50, s58
    s_add_u32 s50, s50, 28672
    buffer_load_dwordx4 v11, s[20:23], s50 offen lds
    s_lshr_b32 s61, s2, 3
    s_and_b32 s61, s61, 3
    s_lshl_b32 s61, s61, 2
    s_add_u32 s61, s61, s43
    s_cmp_lg_u32 s61, 8
    s_cbranch_scc1 k1_nocount2
    s_lshl_b32 s61, s42, 4
    v_mov_b32 v14, s61
    v_mov_b32 v15, 1
    s_mov_b64 exec, 1
    buffer_atomic_add v15, v14, s[32:35], 0 offen sc1
    s_mov_b64 exec, -1
k1_nocount2:
    s_waitcnt lgkmcnt(11)
    v_mfma_f32_32x32x16_bf16 v[64:79], v[204:207], v[180:183], v[64:79]
    ds_read_b128 v[188:191], v29
    ds_read_b64_tr_b16 v[228:229], v30 offset:3072
    s_waitcnt lgkmcnt(11)
    v_mfma_f32_32x32x16_bf16 v[80:95], v[208:211], v[180:183], v[80:95]
    ds_read_b64_tr_b16 v[230:231], v30 offset:3328
    ds_read_b64_tr_b16 v[232:233], v32 offset:6144
    s_waitcnt lgkmcnt(11)
    v_mfma_f32_32x32x16_bf16 v[96:111], v[212:215], v[180:183], v[96:111]
    ds_read_b64_tr_b16 v[234:235], v32 offset:6656
    ds_read_b64_tr_b16 v[236:237], v33 offset:6144
    ds_read_b64_tr_b16 v[238:239], v33 offset:6656
    s_cmp_lg_u32 s43, 1
    s_cbranch_scc1 k1_csA17
    v_mfma_f32_16x16x32_bf16 v[160:163], v[204:207], v[46:49], v[160:163]
    v_mfma_f32_16x16x32_bf16 v[164:167], v[208:211], v[46:49], v[164:167]
    v_mfma_f32_16x16x32_bf16 v[168:171], v[212:215], v[46:49], v[168:171]
k1_csA17:
    s_waitcnt vmcnt(5) lgkmcnt(0)
    s_barrier
    s_add_u32 s100, s101, 7
    s_and_b32 s100, s100, 7
    s_add_u32 m0, s54, 45056
    s_lshl_b32 s50, s100, 7
    s_add_u32 s50, s50, s52
    buffer_load_dwordx4 v8, s[4:7], s50 offen lds
    v_mfma_f32_32x32x16_bf16 v[64:79], v[216:219], v[184:187], v[64:79]
    ds_read_b128 v[176:179], v36
    ds_read_b64_tr_b16 v[192:193], v40 offset:0
    v_lshlrev_b32 v50, 16, v184
    v_and_b32 v51, s48, v184
    v_add_f32 v6, v6, v50
    v_fmac_f32 v54, v50, v50
    v_add_f32 v7, v7, v51
    v_fmac_f32 v55, v51, v51
    v_lshlrev_b32 v52, 16, v185
    v_and_b32 v53, s48, v185
    v_mfma_f32_32x32x16_bf16 v[80:95], v[220:223], v[184:187], v[80:95]
    ds_read_b64_tr_b16 v[194:195], v40 offset:256
    ds_read_b64_tr_b16 v[196:197], v42 offset:0
    v_add_f32 v6, v6, v52
    v_fmac_f32 v54, v52, v52
    v_add_f32 v7, v7, v53
    v_fmac_f32 v55, v53, v53
    v_lshlrev_b32 v50, 16, v186
    v_and_b32 v51, s48, v186
    v_add_f32 v6, v6, v50
    v_fmac_f32 v54, v50, v50
    v_mfma_f32_32x32x16_bf16 v[96:111], v[224:227], v[184:187], v[96:111]
    ds_read_b64_tr_b16 v[198:199], v42 offset:512
    ds_read_b64_tr_b16 v[200:201], v43 offset:0
    ds_read_b64_tr_b16 v[202:203], v43 offset:512
    v_add_f32 v7, v7, v51
    v_fmac_f32 v55, v51, v51
    v_lshlrev_b32 v52, 16, v187
    v_and_b32 v53, s48, v187
    v_add_f32 v6, v6, v52
    v_fmac_f32 v54, v52, v52
    v_add_f32 v7, v7, v53
    v_fmac_f32 v55, v53, v53
    s_cmp_lg_u32 s43, 2
    s_cbranch_scc1 k1_csA18
    v_mfma_f32_16x16x32_bf16 v[160:163], v[216:219], v[46:49], v[160:163]
    v_mfma_f32_16x16x32_bf16 v[164:167], v[220:223], v[46:49], v[164:167]
    v_mfma_f32_16x16x32_bf16 v[168:171], v[224:227], v[46:49], v[168:171]
k1_csA18:
    s_add_u32 m0, s54, 46080
    s_lshl_b32 s50, s100, 7
    s_add_u32 s50, s50, s53
    buffer_load_dwordx4 v9, s[4:7], s50 offen lds
    v_mfma_f32_32x32x16_bf16 v[64:79], v[228:231], v[188:191], v[64:79]
    ds_read_b128 v[180:183], v37
    ds_read_b64_tr_b16 v[204:205], v40 offset:1024
    v_mfma_f32_32x32x16_bf16 v[80:95], v[232:235], v[188:191], v[80:95]
    ds_read_b64_tr_b16 v[206:207], v40 offset:1280
    ds_read_b64_tr_b16 v[208:209], v42 offset:2048
    v_mfma_f32_32x32x16_bf16 v[96:111], v[236:239], v[188:191], v[96:111]
    ds_read_b64_tr_b16 v[210:211], v42 offset:2560
    ds_read_b64_tr_b16 v[212:213], v43 offset:2048
    ds_read_b64_tr_b16 v[214:215], v43 offset:2560
    s_cmp_lg_u32 s43, 3
    s_cbranch_scc1 k1_csA19
    v_mfma_f32_16x16x32_bf16 v[160:163], v[228:231], v[46:49], v[160:163]
    v_mfma_f32_16x16x32_bf16 v[164:167], v[232:235], v[46:49], v[164:167]
    v_mfma_f32_16x16x32_bf16 v[168:171], v[236:239], v[46:49], v[168:171]
k1_csA19:
    s_add_u32 m0, s57, 61440
    s_mul_i32 s50, s100, 196608
    s_add_u32 s50, s50, s55
    buffer_load_dwordx4 v10, s[8:11], s50 offen lds
    s_add_u32 m0, s51, 73728
    s_mul_i32 s50, s100, 229376
    s_add_u32 s50, s50, s58
    buffer_load_dwordx4 v11, s[20:23], s50 offen lds
    s_waitcnt lgkmcnt(11)
    v_mfma_f32_32x32x16_bf16 v[64:79], v[192:195], v[176:179], v[64:79]
    ds_read_b128 v[184:187], v38
    ds_read_b64_tr_b16 v[216:217], v40 offset:2048
    v_lshlrev_b32 v50, 16, v176
    v_and_b32 v51, s48, v176
    v_add_f32 v6, v6, v50
    v_fmac_f32 v54, v50, v50
    v_add_f32 v7, v7, v51
    v_fmac_f32 v55, v51, v51
    v_lshlrev_b32 v52, 16, v177
    v_and_b32 v53, s48, v177
    s_waitcnt lgkmcnt(11)
    v_mfma_f32_32x32x16_bf16 v[80:95], v[196:199], v[176:179], v[80:95]
    ds_read_b64_tr_b16 v[218:219], v40 offset:2304
    ds_read_b64_tr_b16 v[220:221], v42 offset:4096
    v_add_f32 v6, v6, v52
    v_fmac_f32 v54, v52, v52
    v_add_f32 v7, v7, v53
    v_fmac_f32 v55, v53, v53
    v_lshlrev_b32 v50, 16, v178
    v_and_b32 v51, s48, v178
    v_add_f32 v6, v6, v50
    v_fmac_f32 v54, v50, v50
    s_waitcnt lgkmcnt(11)
    v_mfma_f32_32x32x16_bf16 v[96:111], v[200:203], v[176:179], v[96:111]
    ds_read_b64_tr_b16 v[222:223], v42 offset:4608
    ds_read_b64_tr_b16 v[224:225], v43 offset:4096
    ds_read_b64_tr_b16 v[226:227], v43 offset:4608
    v_add_f32 v7, v7, v51
    v_fmac_f32 v55, v51, v51
    v_lshlrev_b32 v52, 16, v179
    v_and_b32 v53, s48, v179
    v_add_f32 v6, v6, v52
    v_fmac_f32 v54, v52, v52
    v_add_f32 v7, v7, v53
    v_fmac_f32 v55, v53, v53
    s_cmp_lg_u32 s43, 0
    s_cbranch_scc1 k1_csA20
    v_mfma_f32_16x16x32_bf16 v[160:163], v[192:195], v[46:49], v[160:163]
    v_mfma_f32_16x16x32_bf16 v[164:167], v[196:199], v[46:49], v[164:167]
    v_mfma_f32_16x16x32_bf16 v[168:171], v[200:203], v[46:49], v[168:171]
k1_csA20:
    s_add_u32 m0, s51, 74752
    s_mul_i32 s50, s100, 229376
    s_add_u32 s50, s50, s58
    s_add_u32 s50, s50, 28672
    buffer_load_dwordx4 v11, s[20:23], s50 offen lds
    s_lshr_b32 s61, s2, 3
    s_and_b32 s61, s61, 3
    s_lshl_b32 s61, s61, 2
    s_add_u32 s61, s61, s43
    s_cmp_lg_u32 s61, 12
    s_cbranch_scc1 k1_nocount3
    s_lshl_b32 s61, s42, 4
    v_mov_b32 v14, s61
    v_mov_b32 v15, 1
    s_mov_b64 exec, 1
    buffer_atomic_add v15, v14, s[32:35], 0 offen sc1
    s_mov_b64 exec, -1
k1_nocount3:
    s_waitcnt lgkmcnt(11)
    v_mfma_f32_32x32x16_bf16 v[64:79], v[204:207], v[180:183], v[64:79]
    ds_read_b128 v[188:191], v39
    ds_read_b64_tr_b16 v[228:229], v40 offset:3072
    s_waitcnt lgkmcnt(11)
    v_mfma_f32_32x32x16_bf16 v[80:95], v[208:211], v[180:183], v[80:95]
    ds_read_b64_tr_b16 v[230:231], v40 offset:3328
    ds_read_b64_tr_b16 v[232:233], v42 offset:6144
    s_waitcnt lgkmcnt(11)
    v_mfma_f32_32x32x16_bf16 v[96:111], v[212:215], v[180:183], v[96:111]
    ds_read_b64_tr_b16 v[234:235], v42 offset:6656
    ds_read_b64_tr_b16 v[236:237], v43 offset:6144
    ds_read_b64_tr_b16 v[238:239], v43 offset:6656
    s_cmp_lg_u32 s43, 1
    s_cbranch_scc1 k1_csA21
    v_mfma_f32_16x16x32_bf16 v[160:163], v[204:207], v[46:49], v[160:163]
    v_mfma_f32_16x16x32_bf16 v[164:167], v[208:211], v[46:49], v[164:167]
    v_mfma_f32_16x16x32_bf16 v[168:171], v[212:215], v[46:49], v[168:171]
k1_csA21:
    s_waitcnt vmcnt(5) lgkmcnt(0)
    s_barrier
    v_and_b32 v154, 1, v1
    v_lshlrev_b32 v154, 5, v154
    v_and_b32 v15, 16, v1
    v_add_u32 v154, v154, v15
    v_and_b32 v15, 2, v1
    v_lshlrev_b32 v15, 2, v15
    v_add_u32 v154, v154, v15
    v_and_b32 v14, 15, v1
    v_lshrrev_b32 v14, 2, v14
    v_lshlrev_b32 v14, 6, v14
    v_add_u32 v154, v154, v14
    s_lshl_b32 s72, s43, 1
    s_cmp_eq_u32 s95, 1
    s_cselect_b32 s62, 8, 9
    s_cselect_b32 s63, 2, 1
    s_lshl_b32 s63, s63, 8
    v_lshlrev_b32 v14, s62, v3
    v_add_u32 v14, v14, v154
    s_lshl_b32 s62, s72, 10
    s_add_u32 s62, s62, 151552
    v_add_u32 v14, s62, v14
    v_add_u32 v15, s63, v14
    ds_read_b64_tr_b16 v[128:129], v14
    ds_read_b64_tr_b16 v[130:131], v15
    s_waitcnt lgkmcnt(0)
    buffer_store_dwordx4 v[128:131], v4, s[36:39], s94 offen sc1
    s_add_u32 s72, s72, 1
    s_cmp_eq_u32 s97, 1
    s_cselect_b32 s62, 8, 9
    s_cselect_b32 s63, 2, 1
    s_lshl_b32 s63, s63, 8
    v_lshlrev_b32 v14, s62, v3
    v_add_u32 v14, v14, v154
    s_lshl_b32 s62, s72, 10
    s_add_u32 s62, s62, 151552
    v_add_u32 v14, s62, v14
    v_add_u32 v15, s63, v14
    ds_read_b64_tr_b16 v[132:133], v14
    ds_read_b64_tr_b16 v[134:135], v15
    s_waitcnt lgkmcnt(0)
    buffer_store_dwordx4 v[132:135], v4, s[36:39], s96 offen sc1
    s_cmp_eq_u32 s99, 1
    s_cselect_b32 s62, 8, 9
    s_cselect_b32 s63, 2, 1
    s_lshl_b32 s63, s63, 8
    v_lshlrev_b32 v14, s62, v3
    v_add_u32 v14, v14, v154
    s_lshl_b32 s62, 8, 10
    s_add_u32 s62, s62, 151552
    v_add_u32 v14, s62, v14
    v_add_u32 v15, s63, v14
    ds_read_b64_tr_b16 v[136:137], v14
    ds_read_b64_tr_b16 v[138:139], v15
    s_waitcnt lgkmcnt(0)
    buffer_store_dwordx4 v[136:139], v4, s[36:39], s98 offen sc1
    v_and_b32 v14, 1, v1
    v_lshlrev_b32 v14, 9, v14
    v_lshlrev_b32 v15, 7, v3
    v_add_u32 v14, v14, v15
    v_and_b32 v15, 15, v1
    v_lshrrev_b32 v15, 2, v15
    v_lshlrev_b32 v15, 5, v15
    v_add_u32 v14, v14, v15
    v_and_b32 v15, 16, v1
    v_add_u32 v14, v14, v15
    v_and_b32 v15, 2, v1
    v_lshlrev_b32 v15, 2, v15
    v_add_u32 v14, v14, v15
    v_add_u32 v14, 160768, v14
    ds_read_b64_tr_b16 v[60:61], v14
    ds_read_b64_tr_b16 v[62:63], v14 offset:256
    v_lshrrev_b32 v13, 2, v2
    v_and_b32 v13, 1, v13
    v_cmp_eq_u32 vcc, 0, v13
    s_waitcnt lgkmcnt(1)
    s_nop 0
    v_cndmask_b32 v56, 0, v60, vcc
    v_cndmask_b32 v57, 0, v61, vcc
    s_waitcnt lgkmcnt(0)
    v_cndmask_b32 v58, 0, v62, vcc
    v_cndmask_b32 v59, 0, v63, vcc
    v_cndmask_b32 v60, v60, 0, vcc
    v_cndmask_b32 v61, v61, 0, vcc
    v_cndmask_b32 v62, v62, 0, vcc
    v_cndmask_b32 v63, v63, 0, vcc
    v_mfma_f32_32x32x16_bf16 v[64:79], v[216:219], v[184:187], v[64:79]
    ds_read_b128 v[176:179], v16
    ds_read_b64_tr_b16 v[192:193], v20 offset:0
    v_lshlrev_b32 v50, 16, v184
    v_and_b32 v51, s48, v184
    v_add_f32 v6, v6, v50
    v_fmac_f32 v54, v50, v50
    v_add_f32 v7, v7, v51
    v_fmac_f32 v55, v51, v51
    v_lshlrev_b32 v52, 16, v185
    v_and_b32 v53, s48, v185
    v_mfma_f32_32x32x16_bf16 v[80:95], v[220:223], v[184:187], v[80:95]
    ds_read_b64_tr_b16 v[194:195], v20 offset:256
    ds_read_b64_tr_b16 v[196:197], v22 offset:0
    v_add_f32 v6, v6, v52
    v_fmac_f32 v54, v52, v52
    v_add_f32 v7, v7, v53
    v_fmac_f32 v55, v53, v53
    v_lshlrev_b32 v50, 16, v186
    v_and_b32 v51, s48, v186
    v_add_f32 v6, v6, v50
    v_fmac_f32 v54, v50, v50
    v_mfma_f32_32x32x16_bf16 v[96:111], v[224:227], v[184:187], v[96:111]
    ds_read_b64_tr_b16 v[198:199], v22 offset:512
    ds_read_b64_tr_b16 v[200:201], v23 offset:0
    ds_read_b64_tr_b16 v[202:203], v23 offset:512
    v_add_f32 v7, v7, v51
    v_fmac_f32 v55, v51, v51
    v_lshlrev_b32 v52, 16, v187
    v_and_b32 v53, s48, v187
    v_add_f32 v6, v6, v52
    v_fmac_f32 v54, v52, v52
    v_add_f32 v7, v7, v53
    v_fmac_f32 v55, v53, v53
    s_cmp_lg_u32 s43, 2
    s_cbranch_scc1 k1_csA22
    v_mfma_f32_16x16x32_bf16 v[160:163], v[216:219], v[46:49], v[160:163]
    v_mfma_f32_16x16x32_bf16 v[164:167], v[220:223], v[46:49], v[164:167]
    v_mfma_f32_16x16x32_bf16 v[168:171], v[224:227], v[46:49], v[168:171]
k1_csA22:
    v_mfma_f32_32x32x16_bf16 v[64:79], v[228:231], v[188:191], v[64:79]
    ds_read_b128 v[180:183], v17
    ds_read_b64_tr_b16 v[204:205], v20 offset:1024
    v_mfma_f32_32x32x16_bf16 v[80:95], v[232:235], v[188:191], v[80:95]
    ds_read_b64_tr_b16 v[206:207], v20 offset:1280
    ds_read_b64_tr_b16 v[208:209], v22 offset:2048
    v_mfma_f32_32x32x16_bf16 v[96:111], v[236:239], v[188:191], v[96:111]
    ds_read_b64_tr_b16 v[210:211], v22 offset:2560
    ds_read_b64_tr_b16 v[212:213], v23 offset:2048
    ds_read_b64_tr_b16 v[214:215], v23 offset:2560
    s_cmp_lg_u32 s43, 3
    s_cbranch_scc1 k1_csA23
    v_mfma_f32_16x16x32_bf16 v[160:163], v[228:231], v[46:49], v[160:163]
    v_mfma_f32_16x16x32_bf16 v[164:167], v[232:235], v[46:49], v[164:167]
    v_mfma_f32_16x16x32_bf16 v[168:171], v[236:239], v[46:49], v[168:171]
k1_csA23:
    s_waitcnt lgkmcnt(11)
    v_mfma_f32_32x32x16_bf16 v[64:79], v[192:195], v[176:179], v[64:79]
    ds_read_b128 v[184:187], v18
    ds_read_b64_tr_b16 v[216:217], v20 offset:2048
    v_lshlrev_b32 v50, 16, v176
    v_and_b32 v51, s48, v176
    v_add_f32 v6, v6, v50
    v_fmac_f32 v54, v50, v50
    v_add_f32 v7, v7, v51
    v_fmac_f32 v55, v51, v51
    v_lshlrev_b32 v52, 16, v177
    v_and_b32 v53, s48, v177
    s_waitcnt lgkmcnt(11)
    v_mfma_f32_32x32x16_bf16 v[80:95], v[196:199], v[176:179], v[80:95]
    ds_read_b64_tr_b16 v[218:219], v20 offset:2304
    ds_read_b64_tr_b16 v[220:221], v22 offset:4096
    v_add_f32 v6, v6, v52
    v_fmac_f32 v54, v52, v52
    v_add_f32 v7, v7, v53
    v_fmac_f32 v55, v53, v53
    v_lshlrev_b32 v50, 16, v178
    v_and_b32 v51, s48, v178
    v_add_f32 v6, v6, v50
    v_fmac_f32 v54, v50, v50
    s_waitcnt lgkmcnt(11)
    v_mfma_f32_32x32x16_bf16 v[96:111], v[200:203], v[176:179], v[96:111]
    ds_read_b64_tr_b16 v[222:223], v22 offset:4608
    ds_read_b64_tr_b16 v[224:225], v23 offset:4096
    ds_read_b64_tr_b16 v[226:227], v23 offset:4608
    v_add_f32 v7, v7, v51
    v_fmac_f32 v55, v51, v51
    v_lshlrev_b32 v52, 16, v179
    v_and_b32 v53, s48, v179
    v_add_f32 v6, v6, v52
    v_fmac_f32 v54, v52, v52
    v_add_f32 v7, v7, v53
    v_fmac_f32 v55, v53, v53
    s_cmp_lg_u32 s43, 0
    s_cbranch_scc1 k1_csA24
    v_mfma_f32_16x16x32_bf16 v[160:163], v[192:195], v[46:49], v[160:163]
    v_mfma_f32_16x16x32_bf16 v[164:167], v[196:199], v[46:49], v[164:167]
    v_mfma_f32_16x16x32_bf16 v[168:171], v[200:203], v[46:49], v[168:171]
k1_csA24:
    s_waitcnt lgkmcnt(11)
    v_mfma_f32_32x32x16_bf16 v[64:79], v[204:207], v[180:183], v[64:79]
    ds_read_b128 v[188:191], v19
    ds_read_b64_tr_b16 v[228:229], v20 offset:3072
    s_waitcnt lgkmcnt(11)
    v_mfma_f32_32x32x16_bf16 v[80:95], v[208:211], v[180:183], v[80:95]
    ds_read_b64_tr_b16 v[230:231], v20 offset:3328
    ds_read_b64_tr_b16 v[232:233], v22 offset:6144
    s_waitcnt lgkmcnt(11)
    v_mfma_f32_32x32x16_bf16 v[96:111], v[212:215], v[180:183], v[96:111]
    ds_read_b64_tr_b16 v[234:235], v22 offset:6656
    ds_read_b64_tr_b16 v[236:237], v23 offset:6144
    ds_read_b64_tr_b16 v[238:239], v23 offset:6656
    s_cmp_lg_u32 s43, 1
    s_cbranch_scc1 k1_csA25
    v_mfma_f32_16x16x32_bf16 v[160:163], v[204:207], v[46:49], v[160:163]
    v_mfma_f32_16x16x32_bf16 v[164:167], v[208:211], v[46:49], v[164:167]
    v_mfma_f32_16x16x32_bf16 v[168:171], v[212:215], v[46:49], v[168:171]
k1_csA25:
    s_waitcnt vmcnt(3) lgkmcnt(0)
    s_barrier
    v_mfma_f32_32x32x16_bf16 v[64:79], v[216:219], v[184:187], v[64:79]
    ds_read_b128 v[176:179], v26
    ds_read_b64_tr_b16 v[192:193], v30 offset:0
    v_lshlrev_b32 v50, 16, v184
    v_and_b32 v51, s48, v184
    v_add_f32 v6, v6, v50
    v_fmac_f32 v54, v50, v50
    v_add_f32 v7, v7, v51
    v_fmac_f32 v55, v51, v51
    v_lshlrev_b32 v52, 16, v185
    v_and_b32 v53, s48, v185
    v_mfma_f32_32x32x16_bf16 v[80:95], v[220:223], v[184:187], v[80:95]
    ds_read_b64_tr_b16 v[194:195], v30 offset:256
    ds_read_b64_tr_b16 v[196:197], v32 offset:0
    v_add_f32 v6, v6, v52
    v_fmac_f32 v54, v52, v52
    v_add_f32 v7, v7, v53
    v_fmac_f32 v55, v53, v53
    v_lshlrev_b32 v50, 16, v186
    v_and_b32 v51, s48, v186
    v_add_f32 v6, v6, v50
    v_fmac_f32 v54, v50, v50
    v_mfma_f32_32x32x16_bf16 v[96:111], v[224:227], v[184:187], v[96:111]
    ds_read_b64_tr_b16 v[198:199], v32 offset:512
    ds_read_b64_tr_b16 v[200:201], v33 offset:0
    ds_read_b64_tr_b16 v[202:203], v33 offset:512
    v_add_f32 v7, v7, v51
    v_fmac_f32 v55, v51, v51
    v_lshlrev_b32 v52, 16, v187
    v_and_b32 v53, s48, v187
    v_add_f32 v6, v6, v52
    v_fmac_f32 v54, v52, v52
    v_add_f32 v7, v7, v53
    v_fmac_f32 v55, v53, v53
    s_cmp_lg_u32 s43, 2
    s_cbranch_scc1 k1_csA26
    v_mfma_f32_16x16x32_bf16 v[160:163], v[216:219], v[46:49], v[160:163]
    v_mfma_f32_16x16x32_bf16 v[164:167], v[220:223], v[46:49], v[164:167]
    v_mfma_f32_16x16x32_bf16 v[168:171], v[224:227], v[46:49], v[168:171]
k1_csA26:
    v_mfma_f32_32x32x16_bf16 v[64:79], v[228:231], v[188:191], v[64:79]
    ds_read_b128 v[180:183], v27
    ds_read_b64_tr_b16 v[204:205], v30 offset:1024
    v_mfma_f32_32x32x16_bf16 v[80:95], v[232:235], v[188:191], v[80:95]
    ds_read_b64_tr_b16 v[206:207], v30 offset:1280
    ds_read_b64_tr_b16 v[208:209], v32 offset:2048
    v_mfma_f32_32x32x16_bf16 v[96:111], v[236:239], v[188:191], v[96:111]
    ds_read_b64_tr_b16 v[210:211], v32 offset:2560
    ds_read_b64_tr_b16 v[212:213], v33 offset:2048
    ds_read_b64_tr_b16 v[214:215], v33 offset:2560
    s_cmp_lg_u32 s43, 3
    s_cbranch_scc1 k1_csA27
    v_mfma_f32_16x16x32_bf16 v[160:163], v[228:231], v[46:49], v[160:163]
    v_mfma_f32_16x16x32_bf16 v[164:167], v[232:235], v[46:49], v[164:167]
    v_mfma_f32_16x16x32_bf16 v[168:171], v[236:239], v[46:49], v[168:171]
k1_csA27:
    s_waitcnt lgkmcnt(11)
    v_mfma_f32_32x32x16_bf16 v[64:79], v[192:195], v[176:179], v[64:79]
    ds_read_b128 v[184:187], v28
    ds_read_b64_tr_b16 v[216:217], v30 offset:2048
    v_lshlrev_b32 v50, 16, v176
    v_and_b32 v51, s48, v176
    v_add_f32 v6, v6, v50
    v_fmac_f32 v54, v50, v50
    v_add_f32 v7, v7, v51
    v_fmac_f32 v55, v51, v51
    v_lshlrev_b32 v52, 16, v177
    v_and_b32 v53, s48, v177
    s_waitcnt lgkmcnt(11)
    v_mfma_f32_32x32x16_bf16 v[80:95], v[196:199], v[176:179], v[80:95]
    ds_read_b64_tr_b16 v[218:219], v30 offset:2304
    ds_read_b64_tr_b16 v[220:221], v32 offset:4096
    v_add_f32 v6, v6, v52
    v_fmac_f32 v54, v52, v52
    v_add_f32 v7, v7, v53
    v_fmac_f32 v55, v53, v53
    v_lshlrev_b32 v50, 16, v178
    v_and_b32 v51, s48, v178
    v_add_f32 v6, v6, v50
    v_fmac_f32 v54, v50, v50
    s_waitcnt lgkmcnt(11)
    v_mfma_f32_32x32x16_bf16 v[96:111], v[200:203], v[176:179], v[96:111]
    ds_read_b64_tr_b16 v[222:223], v32 offset:4608
    ds_read_b64_tr_b16 v[224:225], v33 offset:4096
    ds_read_b64_tr_b16 v[226:227], v33 offset:4608
    v_add_f32 v7, v7, v51
    v_fmac_f32 v55, v51, v51
    v_lshlrev_b32 v52, 16, v179
    v_and_b32 v53, s48, v179
    v_add_f32 v6, v6, v52
    v_fmac_f32 v54, v52, v52
    v_add_f32 v7, v7, v53
    v_fmac_f32 v55, v53, v53
    s_cmp_lg_u32 s43, 0
    s_cbranch_scc1 k1_csA28
    v_mfma_f32_16x16x32_bf16 v[160:163], v[192:195], v[46:49], v[160:163]
    v_mfma_f32_16x16x32_bf16 v[164:167], v[196:199], v[46:49], v[164:167]
    v_mfma_f32_16x16x32_bf16 v[168:171], v[200:203], v[46:49], v[168:171]
k1_csA28:
    s_waitcnt lgkmcnt(11)
    v_mfma_f32_32x32x16_bf16 v[64:79], v[204:207], v[180:183], v[64:79]
    ds_read_b128 v[188:191], v29
    ds_read_b64_tr_b16 v[228:229], v30 offset:3072
    s_waitcnt lgkmcnt(11)
    v_mfma_f32_32x32x16_bf16 v[80:95], v[208:211], v[180:183], v[80:95]
    ds_read_b64_tr_b16 v[230:231], v30 offset:3328
    ds_read_b64_tr_b16 v[232:233], v32 offset:6144
    s_waitcnt lgkmcnt(11)
    v_mfma_f32_32x32x16_bf16 v[96:111], v[212:215], v[180:183], v[96:111]
    ds_read_b64_tr_b16 v[234:235], v32 offset:6656
    ds_read_b64_tr_b16 v[236:237], v33 offset:6144
    ds_read_b64_tr_b16 v[238:239], v33 offset:6656
    s_cmp_lg_u32 s43, 1
    s_cbranch_scc1 k1_csA29
    v_mfma_f32_16x16x32_bf16 v[160:163], v[204:207], v[46:49], v[160:163]
    v_mfma_f32_16x16x32_bf16 v[164:167], v[208:211], v[46:49], v[164:167]
    v_mfma_f32_16x16x32_bf16 v[168:171], v[212:215], v[46:49], v[168:171]
k1_csA29:
    s_waitcnt lgkmcnt(11)
    v_mfma_f32_32x32x16_bf16 v[64:79], v[216:219], v[184:187], v[64:79]
    v_lshlrev_b32 v50, 16, v184
    v_and_b32 v51, s48, v184
    v_add_f32 v6, v6, v50
    v_fmac_f32 v54, v50, v50
    v_add_f32 v7, v7, v51
    v_fmac_f32 v55, v51, v51
    v_lshlrev_b32 v52, 16, v185
    v_and_b32 v53, s48, v185
    s_waitcnt lgkmcnt(9)
    v_mfma_f32_32x32x16_bf16 v[80:95], v[220:223], v[184:187], v[80:95]
    v_add_f32 v6, v6, v52
    v_fmac_f32 v54, v52, v52
    v_add_f32 v7, v7, v53
    v_fmac_f32 v55, v53, v53
    v_lshlrev_b32 v50, 16, v186
    v_and_b32 v51, s48, v186
    v_add_f32 v6, v6, v50
    v_fmac_f32 v54, v50, v50
    s_waitcnt lgkmcnt(7)
    v_mfma_f32_32x32x16_bf16 v[96:111], v[224:227], v[184:187], v[96:111]
    v_add_f32 v7, v7, v51
    v_fmac_f32 v55, v51, v51
    v_lshlrev_b32 v52, 16, v187
    v_and_b32 v53, s48, v187
    v_add_f32 v6, v6, v52
    v_fmac_f32 v54, v52, v52
    v_add_f32 v7, v7, v53
    v_fmac_f32 v55, v53, v53
    s_cmp_lg_u32 s43, 2
    s_cbranch_scc1 k1_csA30
    v_mfma_f32_16x16x32_bf16 v[160:163], v[216:219], v[46:49], v[160:163]
    v_mfma_f32_16x16x32_bf16 v[164:167], v[220:223], v[46:49], v[164:167]
    v_mfma_f32_16x16x32_bf16 v[168:171], v[224:227], v[46:49], v[168:171]
k1_csA30:
    s_waitcnt lgkmcnt(4)
    v_mfma_f32_32x32x16_bf16 v[64:79], v[228:231], v[188:191], v[64:79]
    s_waitcnt lgkmcnt(2)
    v_mfma_f32_32x32x16_bf16 v[80:95], v[232:235], v[188:191], v[80:95]
    s_waitcnt lgkmcnt(0)
    v_mfma_f32_32x32x16_bf16 v[96:111], v[236:239], v[188:191], v[96:111]
    s_cmp_lg_u32 s43, 3
    s_cbranch_scc1 k1_csA31
    v_mfma_f32_16x16x32_bf16 v[160:163], v[228:231], v[46:49], v[160:163]
    v_mfma_f32_16x16x32_bf16 v[164:167], v[232:235], v[46:49], v[164:167]
    v_mfma_f32_16x16x32_bf16 v[168:171], v[236:239], v[46:49], v[168:171]
k1_csA31:
    v_add_f32 v6, v6, v7
    v_add_f32 v7, v54, v55
    s_lshl_b32 s60, s43, 9
    s_add_u32 s60, s60, 143360
    v_lshlrev_b32 v12, 4, v2
    v_lshlrev_b32 v13, 3, v3
    v_add_u32 v12, v12, v13
    v_add_u32 v12, s60, v12
    ds_write_b64 v12, v[6:7]
    v_and_b32 v14, 15, v1
    v_lshlrev_b32 v12, 6, v14
    v_lshrrev_b32 v15, 4, v1
    v_lshlrev_b32 v15, 4, v15
    v_add_u32 v12, v12, v15
    v_add_u32 v12, 147456, v12
    v_cmp_gt_u32 vcc, 2, v14
    s_lshl_b32 s60, s43, 7
    v_add_u32 v12, s60, v12
    s_and_saveexec_b64 s[62:63], vcc
    ds_write_b128 v12, v[160:163] offset:0
    s_mov_b64 exec, s[62:63]
    v_and_b32 v14, 15, v1
    v_lshlrev_b32 v12, 6, v14
    v_lshrrev_b32 v15, 4, v1
    v_lshlrev_b32 v15, 4, v15
    v_add_u32 v12, v12, v15
    v_add_u32 v12, 149504, v12
    v_cmp_gt_u32 vcc, 2, v14
    s_lshl_b32 s60, s43, 7
    v_add_u32 v12, s60, v12
    s_and_saveexec_b64 s[62:63], vcc
    ds_write_b128 v12, v[164:167] offset:0
    ds_write_b128 v12, v[168:171] offset:512
    s_mov_b64 exec, s[62:63]
    s_waitcnt lgkmcnt(0)
    s_barrier
    s_lshl_b32 s60, s40, 9
    s_add_u32 s60, s60, 147456
    v_lshlrev_b32 v12, 2, v2
    v_add_u32 v13, s60, v12
    ds_read_b32 v8, v13 offset:0
    ds_read_b32 v9, v13 offset:128
    ds_read_b32 v10, v13 offset:256
    ds_read_b32 v11, v13 offset:384
    s_lshl_b32 s60, s40, 7
    s_add_u32 s60, s60, 137216
    v_add_u32 v12, s60, v12
    s_waitcnt lgkmcnt(2)
    v_add_f32 v8, v8, v9
    s_waitcnt lgkmcnt(0)
    v_add_f32 v10, v10, v11
    v_add_f32 v8, v8, v10
    ds_write_b32 v12, v8
    s_lshl_b32 s60, s43, 9
    v_lshlrev_b32 v16, 4, v2
    v_add_u32 v16, s60, v16
    v_add_u32 v16, 143360, v16
    ds_read_b128 v[20:23], v16
    ds_read_b128 v[24:27], v16 offset:2048
    s_waitcnt lgkmcnt(1)
    v_add_f32 v18, v20, v22
    s_waitcnt lgkmcnt(0)
    v_add_f32 v19, v24, v26
    v_add_f32 v18, v18, v19
    v_add_f32 v20, v21, v23
    v_add_f32 v19, v25, v27
    v_add_f32 v20, v20, v19
    v_mul_f32 v18, 0x3b000000, v18
    v_mul_f32 v20, 0x3b000000, v20
    v_fma_f32 v20, -v18, v18, v20
    v_max_f32 v20, 0, v20
    v_cvt_pk_bf16_f32 v22, v18, v18
    v_lshlrev_b32 v18, 16, v22
    v_cvt_pk_bf16_f32 v23, v20, v20
    v_lshlrev_b32 v20, 16, v23
    v_add_f32 v20, 0x3727c5ac, v20
    v_cvt_pk_bf16_f32 v23, v20, v20
    v_lshlrev_b32 v20, 16, v23
    v_sqrt_f32 v20, v20
    s_nop 0
    v_cvt_pk_bf16_f32 v23, v20, v20
    v_lshlrev_b32 v20, 16, v23
    v_rcp_f32 v6, v20
    s_nop 0
    v_mul_f32 v7, v18, v6
    s_waitcnt lgkmcnt(0)
    s_barrier
    v_lshlrev_b32 v14, 4, v3
    v_add_u32 v14, 137216, v14
    ds_read_b128 v[16:19], v14 offset:0
    ds_read_b128 v[20:23], v14 offset:32
    ds_read_b128 v[24:27], v14 offset:64
    ds_read_b128 v[28:31], v14 offset:96
    s_waitcnt lgkmcnt(3)
    v_pk_mul_f32 v[16:17], v[16:17], v[6:7] op_sel:[0,1] op_sel_hi:[1,1]
    v_pk_fma_f32 v[64:65], v[64:65], v[6:7], v[16:17] op_sel:[0,0,0] op_sel_hi:[1,0,1] neg_lo:[0,0,1] neg_hi:[0,0,1]
    v_pk_mul_f32 v[18:19], v[18:19], v[6:7] op_sel:[0,1] op_sel_hi:[1,1]
    v_pk_fma_f32 v[66:67], v[66:67], v[6:7], v[18:19] op_sel:[0,0,0] op_sel_hi:[1,0,1] neg_lo:[0,0,1] neg_hi:[0,0,1]
    s_waitcnt lgkmcnt(2)
    v_pk_mul_f32 v[20:21], v[20:21], v[6:7] op_sel:[0,1] op_sel_hi:[1,1]
    v_pk_fma_f32 v[68:69], v[68:69], v[6:7], v[20:21] op_sel:[0,0,0] op_sel_hi:[1,0,1] neg_lo:[0,0,1] neg_hi:[0,0,1]
    v_pk_mul_f32 v[22:23], v[22:23], v[6:7] op_sel:[0,1] op_sel_hi:[1,1]
    v_pk_fma_f32 v[70:71], v[70:71], v[6:7], v[22:23] op_sel:[0,0,0] op_sel_hi:[1,0,1] neg_lo:[0,0,1] neg_hi:[0,0,1]
    s_waitcnt lgkmcnt(1)
    v_pk_mul_f32 v[24:25], v[24:25], v[6:7] op_sel:[0,1] op_sel_hi:[1,1]
    v_pk_fma_f32 v[72:73], v[72:73], v[6:7], v[24:25] op_sel:[0,0,0] op_sel_hi:[1,0,1] neg_lo:[0,0,1] neg_hi:[0,0,1]
    v_pk_mul_f32 v[26:27], v[26:27], v[6:7] op_sel:[0,1] op_sel_hi:[1,1]
    v_pk_fma_f32 v[74:75], v[74:75], v[6:7], v[26:27] op_sel:[0,0,0] op_sel_hi:[1,0,1] neg_lo:[0,0,1] neg_hi:[0,0,1]
    s_waitcnt lgkmcnt(0)
    v_pk_mul_f32 v[28:29], v[28:29], v[6:7] op_sel:[0,1] op_sel_hi:[1,1]
    v_pk_fma_f32 v[76:77], v[76:77], v[6:7], v[28:29] op_sel:[0,0,0] op_sel_hi:[1,0,1] neg_lo:[0,0,1] neg_hi:[0,0,1]
    v_pk_mul_f32 v[30:31], v[30:31], v[6:7] op_sel:[0,1] op_sel_hi:[1,1]
    v_pk_fma_f32 v[78:79], v[78:79], v[6:7], v[30:31] op_sel:[0,0,0] op_sel_hi:[1,0,1] neg_lo:[0,0,1] neg_hi:[0,0,1]
    v_cvt_pk_bf16_f32 v32, v64, v65
    v_cvt_pk_bf16_f32 v33, v66, v67
    v_cvt_pk_bf16_f32 v34, v68, v69
    v_cvt_pk_bf16_f32 v35, v70, v71
    v_cvt_pk_bf16_f32 v36, v72, v73
    v_cvt_pk_bf16_f32 v37, v74, v75
    v_cvt_pk_bf16_f32 v38, v76, v77
    v_cvt_pk_bf16_f32 v39, v78, v79
    v_mfma_f32_32x32x16_bf16 v[112:127], v[56:59], v[32:35], 0
    s_nop 0
    v_mfma_f32_32x32x16_bf16 v[112:127], v[60:63], v[36:39], v[112:127]
    s_nop 11
    v_max3_f32 v40, v112, v113, v114
    v_min3_f32 v41, v112, v113, v114
    v_max3_f32 v40, v40, v115, v116
    v_min3_f32 v41, v41, v115, v116
    v_max3_f32 v40, v40, v117, v118
    v_min3_f32 v41, v41, v117, v118
    v_max3_f32 v40, v40, v119, v120
    v_min3_f32 v41, v41, v119, v120
    v_max3_f32 v40, v40, v121, v122
    v_min3_f32 v41, v41, v121, v122
    v_max3_f32 v40, v40, v123, v124
    v_min3_f32 v41, v41, v123, v124
    v_max3_f32 v40, v40, v125, v126
    v_min3_f32 v41, v41, v125, v126
    v_max_f32 v40, v40, v127
    v_min_f32 v41, v41, v127
    v_mul_f32 v40, s47, v40
    v_mul_f32 v41, s47, v41
    v_fma_f32 v16, v112, s47, -v40
    v_fma_f32 v64, -v112, s47, v41
    v_fma_f32 v17, v113, s47, -v40
    v_fma_f32 v65, -v113, s47, v41
    v_fma_f32 v18, v114, s47, -v40
    v_fma_f32 v66, -v114, s47, v41
    v_fma_f32 v19, v115, s47, -v40
    v_fma_f32 v67, -v115, s47, v41
    v_fma_f32 v20, v116, s47, -v40
    v_fma_f32 v68, -v116, s47, v41
    v_fma_f32 v21, v117, s47, -v40
    v_fma_f32 v69, -v117, s47, v41
    v_fma_f32 v22, v118, s47, -v40
    v_fma_f32 v70, -v118, s47, v41
    v_fma_f32 v23, v119, s47, -v40
    v_fma_f32 v71, -v119, s47, v41
    v_fma_f32 v24, v120, s47, -v40
    v_fma_f32 v72, -v120, s47, v41
    v_fma_f32 v25, v121, s47, -v40
    v_fma_f32 v73, -v121, s47, v41
    v_fma_f32 v26, v122, s47, -v40
    v_fma_f32 v74, -v122, s47, v41
    v_fma_f32 v27, v123, s47, -v40
    v_fma_f32 v75, -v123, s47, v41
    v_fma_f32 v28, v124, s47, -v40
    v_fma_f32 v76, -v124, s47, v41
    v_fma_f32 v29, v125, s47, -v40
    v_fma_f32 v77, -v125, s47, v41
    v_fma_f32 v30, v126, s47, -v40
    v_fma_f32 v78, -v126, s47, v41
    v_fma_f32 v31, v127, s47, -v40
    v_fma_f32 v79, -v127, s47, v41
    v_exp_f32 v16, v16
    v_exp_f32 v64, v64
    v_exp_f32 v17, v17
    v_exp_f32 v65, v65
    v_exp_f32 v18, v18
    v_exp_f32 v66, v66
    v_exp_f32 v19, v19
    v_exp_f32 v67, v67
    v_exp_f32 v20, v20
    v_exp_f32 v68, v68
    v_exp_f32 v21, v21
    v_exp_f32 v69, v69
    v_exp_f32 v22, v22
    v_exp_f32 v70, v70
    v_exp_f32 v23, v23
    v_exp_f32 v71, v71
    v_exp_f32 v24, v24
    v_exp_f32 v72, v72
    v_exp_f32 v25, v25
    v_exp_f32 v73, v73
    v_exp_f32 v26, v26
    v_exp_f32 v74, v74
    v_exp_f32 v27, v27
    v_exp_f32 v75, v75
    v_exp_f32 v28, v28
    v_exp_f32 v76, v76
    v_exp_f32 v29, v29
    v_exp_f32 v77, v77
    v_exp_f32 v30, v30
    v_exp_f32 v78, v78
    v_exp_f32 v31, v31
    v_exp_f32 v79, v79
    v_pk_add_f32 v[42:43], v[16:17], v[18:19]
    v_pk_add_f32 v[42:43], v[42:43], v[20:21]
    v_pk_add_f32 v[42:43], v[42:43], v[22:23]
    v_pk_add_f32 v[42:43], v[42:43], v[24:25]
    v_pk_add_f32 v[42:43], v[42:43], v[26:27]
    v_pk_add_f32 v[42:43], v[42:43], v[28:29]
    v_pk_add_f32 v[42:43], v[42:43], v[30:31]
    v_add_f32 v42, v42, v43
    v_pk_add_f32 v[44:45], v[64:65], v[66:67]
    v_pk_add_f32 v[44:45], v[44:45], v[68:69]
    v_pk_add_f32 v[44:45], v[44:45], v[70:71]
    v_pk_add_f32 v[44:45], v[44:45], v[72:73]
    v_pk_add_f32 v[44:45], v[44:45], v[74:75]
    v_pk_add_f32 v[44:45], v[44:45], v[76:77]
    v_pk_add_f32 v[44:45], v[44:45], v[78:79]
    v_add_f32 v44, v44, v45
    v_rcp_f32 v42, v42
    v_rcp_f32 v44, v44
    v_pk_mul_f32 v[16:17], v[16:17], v[42:43] op_sel_hi:[1,0]
    v_pk_mul_f32 v[64:65], v[64:65], v[44:45] op_sel_hi:[1,0]
    v_pk_mul_f32 v[18:19], v[18:19], v[42:43] op_sel_hi:[1,0]
    v_pk_mul_f32 v[66:67], v[66:67], v[44:45] op_sel_hi:[1,0]
    v_pk_mul_f32 v[20:21], v[20:21], v[42:43] op_sel_hi:[1,0]
    v_pk_mul_f32 v[68:69], v[68:69], v[44:45] op_sel_hi:[1,0]
    v_pk_mul_f32 v[22:23], v[22:23], v[42:43] op_sel_hi:[1,0]
    v_pk_mul_f32 v[70:71], v[70:71], v[44:45] op_sel_hi:[1,0]
    v_pk_mul_f32 v[24:25], v[24:25], v[42:43] op_sel_hi:[1,0]
    v_pk_mul_f32 v[72:73], v[72:73], v[44:45] op_sel_hi:[1,0]
    v_pk_mul_f32 v[26:27], v[26:27], v[42:43] op_sel_hi:[1,0]
    v_pk_mul_f32 v[74:75], v[74:75], v[44:45] op_sel_hi:[1,0]
    v_pk_mul_f32 v[28:29], v[28:29], v[42:43] op_sel_hi:[1,0]
    v_pk_mul_f32 v[76:77], v[76:77], v[44:45] op_sel_hi:[1,0]
    v_pk_mul_f32 v[30:31], v[30:31], v[42:43] op_sel_hi:[1,0]
    v_pk_mul_f32 v[78:79], v[78:79], v[44:45] op_sel_hi:[1,0]
    v_cvt_pk_bf16_f32 v32, v16, v17
    v_cvt_pk_bf16_f32 v33, v18, v19
    v_cvt_pk_bf16_f32 v34, v20, v21
    v_cvt_pk_bf16_f32 v35, v22, v23
    v_cvt_pk_bf16_f32 v36, v24, v25
    v_cvt_pk_bf16_f32 v37, v26, v27
    v_cvt_pk_bf16_f32 v38, v28, v29
    v_cvt_pk_bf16_f32 v39, v30, v31
    v_cvt_pk_bf16_f32 v40, v64, v65
    v_cvt_pk_bf16_f32 v41, v66, v67
    v_cvt_pk_bf16_f32 v42, v68, v69
    v_cvt_pk_bf16_f32 v43, v70, v71
    v_cvt_pk_bf16_f32 v44, v72, v73
    v_cvt_pk_bf16_f32 v45, v74, v75
    v_cvt_pk_bf16_f32 v46, v76, v77
    v_cvt_pk_bf16_f32 v47, v78, v79
    v_and_b32 v16, 15, v2
    v_lshrrev_b32 v17, 4, v2
    v_xor_b32 v17, v17, v3
    v_lshlrev_b32 v17, 6, v17
    v_add_u32 v16, v16, v17
    v_mov_b32 v18, 0x3f80
    v_mov_b32 v19, 0x3f800000
    v_cmp_eq_u32 vcc, 0, v16
    s_nop 1
    v_cndmask_b32 v48, 0, v18, vcc
    v_cmp_eq_u32 vcc, 1, v16
    s_nop 1
    v_cndmask_b32 v48, v48, v19, vcc
    v_cmp_eq_u32 vcc, 2, v16
    s_nop 1
    v_cndmask_b32 v49, 0, v18, vcc
    v_cmp_eq_u32 vcc, 3, v16
    s_nop 1
    v_cndmask_b32 v49, v49, v19, vcc
    v_cmp_eq_u32 vcc, 4, v16
    s_nop 1
    v_cndmask_b32 v50, 0, v18, vcc
    v_cmp_eq_u32 vcc, 5, v16
    s_nop 1
    v_cndmask_b32 v50, v50, v19, vcc
    v_cmp_eq_u32 vcc, 6, v16
    s_nop 1
    v_cndmask_b32 v51, 0, v18, vcc
    v_cmp_eq_u32 vcc, 7, v16
    s_nop 1
    v_cndmask_b32 v51, v51, v19, vcc
    v_cmp_eq_u32 vcc, 8, v16
    s_nop 1
    v_cndmask_b32 v52, 0, v18, vcc
    v_cmp_eq_u32 vcc, 9, v16
    s_nop 1
    v_cndmask_b32 v52, v52, v19, vcc
    v_cmp_eq_u32 vcc, 10, v16
    s_nop 1
    v_cndmask_b32 v53, 0, v18, vcc
    v_cmp_eq_u32 vcc, 11, v16
    s_nop 1
    v_cndmask_b32 v53, v53, v19, vcc
    v_cmp_eq_u32 vcc, 12, v16
    s_nop 1
    v_cndmask_b32 v54, 0, v18, vcc
    v_cmp_eq_u32 vcc, 13, v16
    s_nop 1
    v_cndmask_b32 v54, v54, v19, vcc
    v_cmp_eq_u32 vcc, 14, v16
    s_nop 1
    v_cndmask_b32 v55, 0, v18, vcc
    v_cmp_eq_u32 vcc, 15, v16
    s_nop 1
    v_cndmask_b32 v55, v55, v19, vcc
    v_mfma_f32_32x32x16_bf16 v[112:127], v[32:35], v[48:51], 0
    s_nop 0
    v_mfma_f32_32x32x16_bf16 v[112:127], v[36:39], v[52:55], v[112:127]
    v_mfma_f32_32x32x16_bf16 v[176:191], v[40:43], v[48:51], 0
    v_mfma_f32_32x32x16_bf16 v[176:191], v[44:47], v[52:55], v[176:191]
    s_lshl_b32 s60, s43, 2
    s_add_u32 s60, s60, 136208
    v_mov_b32 v14, s60
    s_mov_b32 s61, 0
k1_sp1:
    ds_read_b32 v15, v14
    s_waitcnt lgkmcnt(0)
    v_readfirstlane_b32 s60, v15
    s_add_u32 s61, s61, 1
    s_cmp_ge_u32 s60, 1
    s_cbranch_scc1 k1_sp1d
    s_cmp_lt_u32 s61, 0x400000
    s_cbranch_scc1 k1_sp1
k1_sp1d:
    s_lshl_b32 s60, s43, 11
    s_add_u32 s60, s60, 0
    v_add_u32 v12, s60, v4
    ds_read_b128 v[48:51], v12
    ds_read_b128 v[52:55], v12 offset:1024
    v_add_f32 v8, v112, v113
    v_add_f32 v10, v114, v115
    v_add_f32 v8, v8, v116
    v_add_f32 v10, v10, v117
    v_add_f32 v8, v8, v118
    v_add_f32 v10, v10, v119
    v_add_f32 v8, v8, v120
    v_add_f32 v10, v10, v121
    v_add_f32 v8, v8, v122
    v_add_f32 v10, v10, v123
    v_add_f32 v8, v8, v124
    v_add_f32 v10, v10, v125
    v_add_f32 v8, v8, v126
    v_add_f32 v10, v10, v127
    v_add_f32 v8, v8, v10
    v_cvt_pk_bf16_f32 v16, v112, v113
    v_cvt_pk_bf16_f32 v17, v114, v115
    v_cvt_pk_bf16_f32 v18, v116, v117
    v_cvt_pk_bf16_f32 v19, v118, v119
    v_cvt_pk_bf16_f32 v20, v120, v121
    v_cvt_pk_bf16_f32 v21, v122, v123
    v_cvt_pk_bf16_f32 v22, v124, v125
    v_cvt_pk_bf16_f32 v23, v126, v127
    v_add_f32 v9, v176, v177
    v_add_f32 v11, v178, v179
    v_add_f32 v9, v9, v180
    v_add_f32 v11, v11, v181
    v_add_f32 v9, v9, v182
    v_add_f32 v11, v11, v183
    v_add_f32 v9, v9, v184
    v_add_f32 v11, v11, v185
    v_add_f32 v9, v9, v186
    v_add_f32 v11, v11, v187
    v_add_f32 v9, v9, v188
    v_add_f32 v11, v11, v189
    v_add_f32 v9, v9, v190
    v_add_f32 v11, v11, v191
    v_add_f32 v9, v9, v11
    v_cvt_pk_bf16_f32 v24, v176, v177
    v_cvt_pk_bf16_f32 v25, v178, v179
    v_cvt_pk_bf16_f32 v26, v180, v181
    v_cvt_pk_bf16_f32 v27, v182, v183
    v_cvt_pk_bf16_f32 v28, v184, v185
    v_cvt_pk_bf16_f32 v29, v186, v187
    v_cvt_pk_bf16_f32 v30, v188, v189
    v_cvt_pk_bf16_f32 v31, v190, v191
    s_waitcnt lgkmcnt(1)
    v_mfma_f32_32x32x16_bf16 v[32:47], v[16:19], v[48:51], 0
    s_waitcnt lgkmcnt(0)
    v_mfma_f32_32x32x16_bf16 v[32:47], v[20:23], v[52:55], v[32:47]
    v_mfma_f32_32x32x16_bf16 v[192:207], v[24:27], v[48:51], 0
    v_mfma_f32_32x32x16_bf16 v[192:207], v[28:31], v[52:55], v[192:207]
    v_and_b32 v10, 16, v1
    v_cmp_ne_u32 vcc, 0, v10
    s_nop 7
    v_cndmask_b32 v64, v32, v40, vcc
    v_cndmask_b32 v65, v33, v41, vcc
    v_cndmask_b32 v66, v34, v42, vcc
    v_cndmask_b32 v67, v35, v43, vcc
    v_cndmask_b32 v68, v36, v44, vcc
    v_cndmask_b32 v69, v37, v45, vcc
    v_cndmask_b32 v70, v38, v46, vcc
    v_cndmask_b32 v71, v39, v47, vcc
    v_cndmask_b32 v72, v192, v200, vcc
    v_cndmask_b32 v73, v193, v201, vcc
    v_cndmask_b32 v74, v194, v202, vcc
    v_cndmask_b32 v75, v195, v203, vcc
    v_cndmask_b32 v76, v196, v204, vcc
    v_cndmask_b32 v77, v197, v205, vcc
    v_cndmask_b32 v78, v198, v206, vcc
    v_cndmask_b32 v79, v199, v207, vcc
    s_lshl_b32 s60, s43, 12
    s_add_u32 s60, s60, 32768
    v_add_u32 v14, s60, v4
    ds_write_b128 v14, v[64:67] offset:0
    ds_write_b128 v14, v[68:71] offset:1024
    ds_write_b128 v14, v[72:75] offset:2048
    ds_write_b128 v14, v[76:79] offset:3072
    s_lshl_b32 s60, s43, 11
    s_add_u32 s60, s60, 0
    v_lshlrev_b32 v11, 3, v1
    v_add_u32 v14, s60, v11
    ds_write_b64 v14, v[8:9]
    s_waitcnt lgkmcnt(0)
    v_mov_b32 v14, 136192
    v_mov_b32 v10, 1
    s_mov_b64 exec, 1
    ds_add_rtn_u32 v10, v14, v10
    s_waitcnt lgkmcnt(0)
    s_mov_b64 exec, -1
    v_readfirstlane_b32 s59, v10
    s_nop 0
    s_cmp_lg_u32 s59, 3
    s_cbranch_scc1 k1_nopub
    v_add_u32 v14, 32768, v4
    ds_read_b128 v[16:19], v14 offset:0
    ds_read_b128 v[20:23], v14 offset:1024
    ds_read_b128 v[24:27], v14 offset:2048
    ds_read_b128 v[28:31], v14 offset:3072
    ds_read_b128 v[32:35], v14 offset:4096
    ds_read_b128 v[36:39], v14 offset:5120
    ds_read_b128 v[40:43], v14 offset:6144
    ds_read_b128 v[44:47], v14 offset:7168
    ds_read_b128 v[64:67], v14 offset:8192
    ds_read_b128 v[68:71], v14 offset:9216
    ds_read_b128 v[72:75], v14 offset:10240
    ds_read_b128 v[76:79], v14 offset:11264
    ds_read_b128 v[192:195], v14 offset:12288
    ds_read_b128 v[196:199], v14 offset:13312
    ds_read_b128 v[200:203], v14 offset:14336
    ds_read_b128 v[204:207], v14 offset:15360
    v_add_u32 v14, 0, v11
    ds_read_b64 v[48:49], v14 offset:0
    ds_read_b64 v[50:51], v14 offset:2048
    ds_read_b64 v[52:53], v14 offset:4096
    ds_read_b64 v[54:55], v14 offset:6144
    s_waitcnt lgkmcnt(15)
    v_add_f32 v16, v16, v32
    s_waitcnt lgkmcnt(7)
    v_add_f32 v192, v192, v64
    v_add_f32 v16, v16, v192
    v_add_f32 v17, v17, v33
    v_add_f32 v193, v193, v65
    v_add_f32 v17, v17, v193
    v_add_f32 v18, v18, v34
    v_add_f32 v194, v194, v66
    v_add_f32 v18, v18, v194
    v_add_f32 v19, v19, v35
    v_add_f32 v195, v195, v67
    v_add_f32 v19, v19, v195
    v_add_f32 v20, v20, v36
    s_waitcnt lgkmcnt(6)
    v_add_f32 v196, v196, v68
    v_add_f32 v20, v20, v196
    v_add_f32 v21, v21, v37
    v_add_f32 v197, v197, v69
    v_add_f32 v21, v21, v197
    v_add_f32 v22, v22, v38
    v_add_f32 v198, v198, v70
    v_add_f32 v22, v22, v198
    v_add_f32 v23, v23, v39
    v_add_f32 v199, v199, v71
    v_add_f32 v23, v23, v199
    v_add_f32 v24, v24, v40
    s_waitcnt lgkmcnt(5)
    v_add_f32 v200, v200, v72
    v_add_f32 v24, v24, v200
    v_add_f32 v25, v25, v41
    v_add_f32 v201, v201, v73
    v_add_f32 v25, v25, v201
    v_add_f32 v26, v26, v42
    v_add_f32 v202, v202, v74
    v_add_f32 v26, v26, v202
    v_add_f32 v27, v27, v43
    v_add_f32 v203, v203, v75
    v_add_f32 v27, v27, v203
    v_add_f32 v28, v28, v44
    s_waitcnt lgkmcnt(4)
    v_add_f32 v204, v204, v76
    v_add_f32 v28, v28, v204
    v_add_f32 v29, v29, v45
    v_add_f32 v205, v205, v77
    v_add_f32 v29, v29, v205
    v_add_f32 v30, v30, v46
    v_add_f32 v206, v206, v78
    v_add_f32 v30, v30, v206
    v_add_f32 v31, v31, v47
    v_add_f32 v207, v207, v79
    v_add_f32 v31, v31, v207
    s_waitcnt lgkmcnt(2)
    v_add_f32 v48, v48, v50
    s_waitcnt lgkmcnt(0)
    v_add_f32 v52, v52, v54
    v_add_f32 v48, v48, v52
    v_add_f32 v49, v49, v51
    v_add_f32 v53, v53, v55
    v_add_f32 v49, v49, v53
    s_lshl_b32 s60, s42, 4
    s_add_u32 s60, s60, s41
    s_lshl_b32 s61, s60, 12
    s_add_u32 s61, s61, 13631488
    buffer_store_dwordx4 v[16:19], v4, s[36:39], s61 offen offset:0 sc1
    buffer_store_dwordx4 v[20:23], v4, s[36:39], s61 offen offset:1024 sc1
    buffer_store_dwordx4 v[24:27], v4, s[36:39], s61 offen offset:2048 sc1
    buffer_store_dwordx4 v[28:31], v4, s[36:39], s61 offen offset:3072 sc1
    v_permlane32_swap_b32 v48, v49
    v_add_f32 v48, v48, v49
    s_lshl_b32 s61, s60, 8
    s_add_u32 s61, s61, 14680064
    v_lshlrev_b32 v14, 2, v1
    buffer_store_dword v48, v14, s[36:39], s61 offen sc1
    s_waitcnt vmcnt(0)
    s_lshl_b32 s60, s42, 7
    s_lshl_b32 s61, s41, 2
    s_add_u32 s60, s60, s61
    s_add_u32 s60, s60, 15204352
    v_mov_b32 v14, s60
    v_mov_b32 v15, 1
    s_mov_b64 exec, 1
    buffer_store_dword v15, v14, s[36:39], 0 offen sc1
    s_mov_b64 exec, -1
k1_nopub:
    s_nop 15
    s_nop 3
    s_waitcnt vmcnt(0)
    v_mov_b32 v14, 136240
    v_mov_b32 v15, 1
    s_mov_b64 exec, 1
    ds_add_rtn_u32 v15, v14, v15
    s_waitcnt lgkmcnt(0)
    s_mov_b64 exec, -1
    v_readfirstlane_b32 s61, v15
    s_nop 0
    s_cmp_lg_u32 s61, 3
    s_cbranch_scc1 k1_wfd
    s_lshl_b32 s61, s2, 2
    s_add_u32 s61, s61, 15216640
    v_mov_b32 v14, s61
    v_mov_b32 v15, 1
    s_mov_b64 exec, 1
    buffer_store_dword v15, v14, s[36:39], 0 offen sc1
    s_mov_b64 exec, -1
k1_wfd:
    v_lshlrev_b32 v14, 4, v3
    v_add_u32 v14, 137728, v14
    ds_read_b128 v[16:19], v14 offset:0
    ds_read_b128 v[20:23], v14 offset:32
    ds_read_b128 v[24:27], v14 offset:64
    ds_read_b128 v[28:31], v14 offset:96
    v_lshlrev_b32 v14, 4, v3
    v_add_u32 v14, 138240, v14
    ds_read_b128 v[32:35], v14 offset:0
    ds_read_b128 v[36:39], v14 offset:32
    ds_read_b128 v[40:43], v14 offset:64
    ds_read_b128 v[44:47], v14 offset:96
    s_waitcnt lgkmcnt(3)
    v_pk_fma_f32 v[16:17], v[16:17], v[6:7], v[32:33] op_sel:[0,1,0] op_sel_hi:[1,1,1] neg_lo:[0,0,1] neg_hi:[0,0,1]
    v_pk_fma_f32 v[80:81], v[80:81], v[6:7], v[16:17] op_sel:[0,0,0] op_sel_hi:[1,0,1] neg_lo:[0,0,1] neg_hi:[0,0,1]
    v_max_f32 v80, 0, v80
    v_max_f32 v81, 0, v81
    v_pk_mul_f32 v[80:81], v[80:81], v[80:81]
    v_pk_fma_f32 v[18:19], v[18:19], v[6:7], v[34:35] op_sel:[0,1,0] op_sel_hi:[1,1,1] neg_lo:[0,0,1] neg_hi:[0,0,1]
    v_pk_fma_f32 v[82:83], v[82:83], v[6:7], v[18:19] op_sel:[0,0,0] op_sel_hi:[1,0,1] neg_lo:[0,0,1] neg_hi:[0,0,1]
    v_max_f32 v82, 0, v82
    v_max_f32 v83, 0, v83
    v_pk_mul_f32 v[82:83], v[82:83], v[82:83]
    s_waitcnt lgkmcnt(2)
    v_pk_fma_f32 v[20:21], v[20:21], v[6:7], v[36:37] op_sel:[0,1,0] op_sel_hi:[1,1,1] neg_lo:[0,0,1] neg_hi:[0,0,1]
    v_pk_fma_f32 v[84:85], v[84:85], v[6:7], v[20:21] op_sel:[0,0,0] op_sel_hi:[1,0,1] neg_lo:[0,0,1] neg_hi:[0,0,1]
    v_max_f32 v84, 0, v84
    v_max_f32 v85, 0, v85
    v_pk_mul_f32 v[84:85], v[84:85], v[84:85]
    v_pk_fma_f32 v[22:23], v[22:23], v[6:7], v[38:39] op_sel:[0,1,0] op_sel_hi:[1,1,1] neg_lo:[0,0,1] neg_hi:[0,0,1]
    v_pk_fma_f32 v[86:87], v[86:87], v[6:7], v[22:23] op_sel:[0,0,0] op_sel_hi:[1,0,1] neg_lo:[0,0,1] neg_hi:[0,0,1]
    v_max_f32 v86, 0, v86
    v_max_f32 v87, 0, v87
    v_pk_mul_f32 v[86:87], v[86:87], v[86:87]
    s_waitcnt lgkmcnt(1)
    v_pk_fma_f32 v[24:25], v[24:25], v[6:7], v[40:41] op_sel:[0,1,0] op_sel_hi:[1,1,1] neg_lo:[0,0,1] neg_hi:[0,0,1]
    v_pk_fma_f32 v[88:89], v[88:89], v[6:7], v[24:25] op_sel:[0,0,0] op_sel_hi:[1,0,1] neg_lo:[0,0,1] neg_hi:[0,0,1]
    v_max_f32 v88, 0, v88
    v_max_f32 v89, 0, v89
    v_pk_mul_f32 v[88:89], v[88:89], v[88:89]
    v_pk_fma_f32 v[26:27], v[26:27], v[6:7], v[42:43] op_sel:[0,1,0] op_sel_hi:[1,1,1] neg_lo:[0,0,1] neg_hi:[0,0,1]
    v_pk_fma_f32 v[90:91], v[90:91], v[6:7], v[26:27] op_sel:[0,0,0] op_sel_hi:[1,0,1] neg_lo:[0,0,1] neg_hi:[0,0,1]
    v_max_f32 v90, 0, v90
    v_max_f32 v91, 0, v91
    v_pk_mul_f32 v[90:91], v[90:91], v[90:91]
    s_waitcnt lgkmcnt(0)
    v_pk_fma_f32 v[28:29], v[28:29], v[6:7], v[44:45] op_sel:[0,1,0] op_sel_hi:[1,1,1] neg_lo:[0,0,1] neg_hi:[0,0,1]
    v_pk_fma_f32 v[92:93], v[92:93], v[6:7], v[28:29] op_sel:[0,0,0] op_sel_hi:[1,0,1] neg_lo:[0,0,1] neg_hi:[0,0,1]
    v_max_f32 v92, 0, v92
    v_max_f32 v93, 0, v93
    v_pk_mul_f32 v[92:93], v[92:93], v[92:93]
    v_pk_fma_f32 v[30:31], v[30:31], v[6:7], v[46:47] op_sel:[0,1,0] op_sel_hi:[1,1,1] neg_lo:[0,0,1] neg_hi:[0,0,1]
    v_pk_fma_f32 v[94:95], v[94:95], v[6:7], v[30:31] op_sel:[0,0,0] op_sel_hi:[1,0,1] neg_lo:[0,0,1] neg_hi:[0,0,1]
    v_max_f32 v94, 0, v94
    v_max_f32 v95, 0, v95
    v_pk_mul_f32 v[94:95], v[94:95], v[94:95]
    v_cvt_pk_bf16_f32 v208, v80, v81
    v_cvt_pk_bf16_f32 v209, v82, v83
    v_cvt_pk_bf16_f32 v210, v84, v85
    v_cvt_pk_bf16_f32 v211, v86, v87
    v_cvt_pk_bf16_f32 v212, v88, v89
    v_cvt_pk_bf16_f32 v213, v90, v91
    v_cvt_pk_bf16_f32 v214, v92, v93
    v_cvt_pk_bf16_f32 v215, v94, v95
    s_mul_i32 s60, s49, 144
    s_lshl_b32 s61, s45, 1
    s_add_u32 s60, s60, s61
    s_add_u32 s60, s60, 0
    s_lshl_b32 s60, s60, 10
    buffer_store_dwordx4 v[208:211], v4, s[36:39], s60 offen sc1
    buffer_store_dwordx4 v[212:215], v4, s[36:39], s60 offen offset:1024 sc1
    v_lshlrev_b32 v14, 4, v3
    v_add_u32 v14, 137856, v14
    ds_read_b128 v[16:19], v14 offset:0
    ds_read_b128 v[20:23], v14 offset:32
    ds_read_b128 v[24:27], v14 offset:64
    ds_read_b128 v[28:31], v14 offset:96
    v_lshlrev_b32 v14, 4, v3
    v_add_u32 v14, 138368, v14
    ds_read_b128 v[32:35], v14 offset:0
    ds_read_b128 v[36:39], v14 offset:32
    ds_read_b128 v[40:43], v14 offset:64
    ds_read_b128 v[44:47], v14 offset:96
    s_waitcnt lgkmcnt(3)
    v_pk_fma_f32 v[16:17], v[16:17], v[6:7], v[32:33] op_sel:[0,1,0] op_sel_hi:[1,1,1] neg_lo:[0,0,1] neg_hi:[0,0,1]
    v_pk_fma_f32 v[96:97], v[96:97], v[6:7], v[16:17] op_sel:[0,0,0] op_sel_hi:[1,0,1] neg_lo:[0,0,1] neg_hi:[0,0,1]
    v_max_f32 v96, 0, v96
    v_max_f32 v97, 0, v97
    v_pk_mul_f32 v[96:97], v[96:97], v[96:97]
    v_pk_fma_f32 v[18:19], v[18:19], v[6:7], v[34:35] op_sel:[0,1,0] op_sel_hi:[1,1,1] neg_lo:[0,0,1] neg_hi:[0,0,1]
    v_pk_fma_f32 v[98:99], v[98:99], v[6:7], v[18:19] op_sel:[0,0,0] op_sel_hi:[1,0,1] neg_lo:[0,0,1] neg_hi:[0,0,1]
    v_max_f32 v98, 0, v98
    v_max_f32 v99, 0, v99
    v_pk_mul_f32 v[98:99], v[98:99], v[98:99]
    s_waitcnt lgkmcnt(2)
    v_pk_fma_f32 v[20:21], v[20:21], v[6:7], v[36:37] op_sel:[0,1,0] op_sel_hi:[1,1,1] neg_lo:[0,0,1] neg_hi:[0,0,1]
    v_pk_fma_f32 v[100:101], v[100:101], v[6:7], v[20:21] op_sel:[0,0,0] op_sel_hi:[1,0,1] neg_lo:[0,0,1] neg_hi:[0,0,1]
    v_max_f32 v100, 0, v100
    v_max_f32 v101, 0, v101
    v_pk_mul_f32 v[100:101], v[100:101], v[100:101]
    v_pk_fma_f32 v[22:23], v[22:23], v[6:7], v[38:39] op_sel:[0,1,0] op_sel_hi:[1,1,1] neg_lo:[0,0,1] neg_hi:[0,0,1]
    v_pk_fma_f32 v[102:103], v[102:103], v[6:7], v[22:23] op_sel:[0,0,0] op_sel_hi:[1,0,1] neg_lo:[0,0,1] neg_hi:[0,0,1]
    v_max_f32 v102, 0, v102
    v_max_f32 v103, 0, v103
    v_pk_mul_f32 v[102:103], v[102:103], v[102:103]
    s_waitcnt lgkmcnt(1)
    v_pk_fma_f32 v[24:25], v[24:25], v[6:7], v[40:41] op_sel:[0,1,0] op_sel_hi:[1,1,1] neg_lo:[0,0,1] neg_hi:[0,0,1]
    v_pk_fma_f32 v[104:105], v[104:105], v[6:7], v[24:25] op_sel:[0,0,0] op_sel_hi:[1,0,1] neg_lo:[0,0,1] neg_hi:[0,0,1]
    v_max_f32 v104, 0, v104
    v_max_f32 v105, 0, v105
    v_pk_mul_f32 v[104:105], v[104:105], v[104:105]
    v_pk_fma_f32 v[26:27], v[26:27], v[6:7], v[42:43] op_sel:[0,1,0] op_sel_hi:[1,1,1] neg_lo:[0,0,1] neg_hi:[0,0,1]
    v_pk_fma_f32 v[106:107], v[106:107], v[6:7], v[26:27] op_sel:[0,0,0] op_sel_hi:[1,0,1] neg_lo:[0,0,1] neg_hi:[0,0,1]
    v_max_f32 v106, 0, v106
    v_max_f32 v107, 0, v107
    v_pk_mul_f32 v[106:107], v[106:107], v[106:107]
    s_waitcnt lgkmcnt(0)
    v_pk_fma_f32 v[28:29], v[28:29], v[6:7], v[44:45] op_sel:[0,1,0] op_sel_hi:[1,1,1] neg_lo:[0,0,1] neg_hi:[0,0,1]
    v_pk_fma_f32 v[108:109], v[108:109], v[6:7], v[28:29] op_sel:[0,0,0] op_sel_hi:[1,0,1] neg_lo:[0,0,1] neg_hi:[0,0,1]
    v_max_f32 v108, 0, v108
    v_max_f32 v109, 0, v109
    v_pk_mul_f32 v[108:109], v[108:109], v[108:109]
    v_pk_fma_f32 v[30:31], v[30:31], v[6:7], v[46:47] op_sel:[0,1,0] op_sel_hi:[1,1,1] neg_lo:[0,0,1] neg_hi:[0,0,1]
    v_pk_fma_f32 v[110:111], v[110:111], v[6:7], v[30:31] op_sel:[0,0,0] op_sel_hi:[1,0,1] neg_lo:[0,0,1] neg_hi:[0,0,1]
    v_max_f32 v110, 0, v110
    v_max_f32 v111, 0, v111
    v_pk_mul_f32 v[110:111], v[110:111], v[110:111]
    v_cvt_pk_bf16_f32 v216, v96, v97
    v_cvt_pk_bf16_f32 v217, v98, v99
    v_cvt_pk_bf16_f32 v218, v100, v101
    v_cvt_pk_bf16_f32 v219, v102, v103
    v_cvt_pk_bf16_f32 v220, v104, v105
    v_cvt_pk_bf16_f32 v221, v106, v107
    v_cvt_pk_bf16_f32 v222, v108, v109
    v_cvt_pk_bf16_f32 v223, v110, v111
    s_mul_i32 s60, s49, 144
    s_lshl_b32 s61, s45, 1
    s_add_u32 s60, s60, s61
    s_add_u32 s60, s60, 2
    s_lshl_b32 s60, s60, 10
    buffer_store_dwordx4 v[216:219], v4, s[36:39], s60 offen sc1
    buffer_store_dwordx4 v[220:223], v4, s[36:39], s60 offen offset:1024 sc1
    s_waitcnt vmcnt(0)
    v_mov_b32 v14, 136236
    v_mov_b32 v15, 1
    s_mov_b64 exec, 1
    ds_add_rtn_u32 v15, v14, v15
    s_waitcnt lgkmcnt(0)
    s_mov_b64 exec, -1
    v_readfirstlane_b32 s61, v15
    s_nop 0
    s_cmp_lg_u32 s61, 7
    s_cbranch_scc1 k1_hdA
    s_lshl_b32 s61, s41, 7
    s_lshl_b32 s60, s42, 2
    s_add_u32 s61, s61, s60
    s_add_u32 s61, s61, 15208448
    v_mov_b32 v14, s61
    v_mov_b32 v15, 1
    s_mov_b64 exec, 1
    buffer_store_dword v15, v14, s[36:39], 0 offen sc1
    s_mov_b64 exec, -1
k1_hdA:
    s_and_b32 s64, s2, 7
    s_lshl_b32 s64, s64, 2
    s_lshr_b32 s65, s2, 6
    s_add_u32 s64, s64, s65
    s_lshr_b32 s65, s2, 3
    s_and_b32 s65, s65, 7
    s_lshl_b32 s64, s64, 1
    s_lshl_b32 s65, s65, 1
    s_lshr_b32 s68, s40, 1
    s_add_u32 s68, s68, 2
    s_and_b32 s68, s68, 3
    s_and_b32 s69, s68, 1
    s_add_u32 s70, s64, s69
    s_add_u32 s71, s65, s69
    s_cmp_ge_u32 s68, 2
    s_cselect_b32 s70, s71, s70
    s_cselect_b32 s71, 0xa00000, 0
    s_mul_i32 s66, s70, 147456
    s_add_u32 s66, s66, s71
    s_and_b32 s71, s40, 1
    s_mul_i32 s71, s71, 4096
    s_add_u32 s66, s66, s71
    s_mul_i32 s67, s68, 8192
    s_add_u32 s67, s67, s71
    s_load_dwordx4 s[68:71], s[0:1], 64
    v_mov_b32 v14, 136196
    s_mov_b32 s61, 0
k2_spk:
    ds_read_b32 v15, v14
    s_waitcnt lgkmcnt(0)
    v_readfirstlane_b32 s60, v15
    s_add_u32 s61, s61, 1
    s_cmp_ge_u32 s60, 1
    s_cbranch_scc1 k2_spkd
    s_sleep 1
    s_cmp_lt_u32 s61, 0x400000
    s_cbranch_scc1 k2_spk
k2_spkd:
    v_lshlrev_b32 v14, 2, v1
    s_mov_b32 s61, 0
k2_pollc:
    buffer_load_dword v10, v14, s[32:35], 0 offen sc1
    v_and_b32 v15, 3, v1
    s_waitcnt vmcnt(0)
    v_cmp_gt_u32 vcc, 16, v10
    v_cmp_eq_u32 s[62:63], 0, v15
    s_add_u32 s61, s61, 1
    s_and_b64 vcc, vcc, s[62:63]
    s_cmp_eq_u64 vcc, 0
    s_cbranch_scc1 k2_pollcok
    s_sleep 2
    s_cmp_lt_u32 s61, 0x400000
    s_cbranch_scc1 k2_pollc
k2_pollcok:
    v_and_b32 v14, 31, v1
    v_lshlrev_b32 v14, 2, v14
    s_lshl_b32 s62, s65, 6
    s_add_u32 s62, s62, 15216640
    s_mov_b32 s61, 0
k2_pollw:
    buffer_load_dword v10, v14, s[36:39], s62 offen sc1
    s_waitcnt vmcnt(0)
    v_cmp_ne_u32 vcc, 1, v10
    s_add_u32 s61, s61, 1
    s_cmp_eq_u64 vcc, 0
    s_cbranch_scc1 k2_wok
    s_sleep 2
    s_cmp_lt_u32 s61, 0x400000
    s_cbranch_scc1 k2_pollw
k2_wok:
    v_and_b32 v14, 15, v1
    v_lshlrev_b32 v14, 2, v14
    s_lshr_b32 s62, s64, 2
    s_lshl_b32 s62, s62, 7
    s_add_u32 s62, s62, 15208448
    s_mov_b32 s61, 0
k2_pollh:
    buffer_load_dword v10, v14, s[36:39], s62 offen sc1
    s_waitcnt vmcnt(0)
    v_cmp_ne_u32 vcc, 1, v10
    s_add_u32 s61, s61, 1
    s_cmp_eq_u64 vcc, 0
    s_cbranch_scc1 k2_hok
    s_sleep 2
    s_cmp_lt_u32 s61, 0x400000
    s_cbranch_scc1 k2_pollh
k2_hok:
    s_lshr_b32 s60, s40, 1
    s_add_u32 s61, s64, s60
    s_mul_i32 s72, s61, 147456
    s_and_b32 s61, s40, 1
    s_mul_i32 s61, s61, 4096
    s_add_u32 s72, s72, s61
    s_mul_i32 s73, s60, 8192
    s_add_u32 s73, s73, s61
    s_add_u32 m0, s73, 0
    s_nop 0
    buffer_load_dwordx4 v4, s[36:39], s72 offen offset:0 sc1 lds
    buffer_load_dwordx4 v4, s[36:39], s72 offen offset:1024 sc1 lds
    buffer_load_dwordx4 v4, s[36:39], s72 offen offset:2048 sc1 lds
    buffer_load_dwordx4 v4, s[36:39], s72 offen offset:3072 sc1 lds
    s_add_u32 s72, s72, 8192
    s_add_u32 m0, s67, 0
    s_nop 0
    buffer_load_dwordx4 v4, s[36:39], s66 offen offset:0 sc1 lds
    buffer_load_dwordx4 v4, s[36:39], s66 offen offset:1024 sc1 lds
    buffer_load_dwordx4 v4, s[36:39], s66 offen offset:2048 sc1 lds
    buffer_load_dwordx4 v4, s[36:39], s66 offen offset:3072 sc1 lds
    s_add_u32 s66, s66, 8192
    s_add_u32 m0, s73, 32768
    s_nop 0
    buffer_load_dwordx4 v4, s[36:39], s72 offen offset:0 sc1 lds
    buffer_load_dwordx4 v4, s[36:39], s72 offen offset:1024 sc1 lds
    buffer_load_dwordx4 v4, s[36:39], s72 offen offset:2048 sc1 lds
    buffer_load_dwordx4 v4, s[36:39], s72 offen offset:3072 sc1 lds
    s_add_u32 s72, s72, 8192
    s_add_u32 m0, s67, 32768
    s_nop 0
    buffer_load_dwordx4 v4, s[36:39], s66 offen offset:0 sc1 lds
    buffer_load_dwordx4 v4, s[36:39], s66 offen offset:1024 sc1 lds
    buffer_load_dwordx4 v4, s[36:39], s66 offen offset:2048 sc1 lds
    buffer_load_dwordx4 v4, s[36:39], s66 offen offset:3072 sc1 lds
    s_add_u32 s66, s66, 8192
    s_add_u32 m0, s73, 65536
    s_nop 0
    buffer_load_dwordx4 v4, s[36:39], s72 offen offset:0 sc1 lds
    buffer_load_dwordx4 v4, s[36:39], s72 offen offset:1024 sc1 lds
    buffer_load_dwordx4 v4, s[36:39], s72 offen offset:2048 sc1 lds
    buffer_load_dwordx4 v4, s[36:39], s72 offen offset:3072 sc1 lds
    s_add_u32 s72, s72, 8192
    s_add_u32 m0, s67, 65536
    s_nop 0
    buffer_load_dwordx4 v4, s[36:39], s66 offen offset:0 sc1 lds
    buffer_load_dwordx4 v4, s[36:39], s66 offen offset:1024 sc1 lds
    buffer_load_dwordx4 v4, s[36:39], s66 offen offset:2048 sc1 lds
    buffer_load_dwordx4 v4, s[36:39], s66 offen offset:3072 sc1 lds
    s_add_u32 s66, s66, 8192
    s_waitcnt lgkmcnt(0)
    s_barrier
    s_mov_b32 s28, s68
    s_mov_b32 s29, s69
    s_mov_b32 s30, 1024
    s_mov_b32 s31, 0x20000
    s_mov_b32 s16, s70
    s_mov_b32 s17, s71
    s_mov_b32 s18, 0x200000
    s_mov_b32 s19, 0x20000
    s_lshr_b32 s68, s43, 1
    s_and_b32 s69, s43, 1
    s_add_u32 s60, s64, s68
    s_lshl_b32 s60, s60, 5
    v_add_u32 v6, s60, v2
    v_lshlrev_b32 v6, 10, v6
    v_lshlrev_b32 v5, 5, v3
    s_add_u32 s60, s65, s69
    s_lshl_b32 s60, s60, 6
    s_lshl_b32 s61, s44, 4
    s_add_u32 s60, s60, s61
    v_add_u32 v5, s60, v5
    v_add_u32 v6, v6, v5
    s_mul_i32 s60, s68, 8192
    s_mul_i32 s61, s44, 4096
    s_add_u32 s60, s60, s61
    v_add_u32 v16, s60, v4
    s_mul_i32 s60, s69, 8192
    s_add_u32 s60, s60, s61
    s_add_u32 s60, s60, 16384
    v_add_u32 v19, s60, v4
    v_add_u32 v17, 65536, v16
    v_add_u32 v20, 65536, v19
    v_add_u32 v18, 131072, v16
    v_add_u32 v21, 131072, v19
    s_xor_b32 s60, s40, 4
    s_lshl_b32 s60, s60, 12
    v_add_u32 v22, s60, v4
    s_lshl_b32 s60, s40, 12
    v_add_u32 v23, s60, v4
    v_and_b32 v28, 15, v1
    v_lshlrev_b32 v28, 2, v28
    s_lshr_b32 s62, s64, 2
    s_lshl_b32 s62, s62, 7
    s_add_u32 s62, s62, 15212544
    s_waitcnt vmcnt(16) lgkmcnt(0)
    s_barrier
    ds_read_b128 v[128:131], v16 offset:0
    ds_read_b128 v[132:135], v19 offset:0
    ds_read_b128 v[136:139], v16 offset:1024
    ds_read_b128 v[140:143], v19 offset:1024
    ds_read_b128 v[144:147], v16 offset:2048
    ds_read_b128 v[148:151], v19 offset:2048
    ds_read_b128 v[152:155], v16 offset:3072
    ds_read_b128 v[156:159], v19 offset:3072
    s_add_u32 m0, s67, 98304
    s_nop 0
    buffer_load_dwordx4 v4, s[36:39], s66 offen offset:0 sc1 lds
    buffer_load_dwordx4 v4, s[36:39], s66 offen offset:1024 sc1 lds
    buffer_load_dwordx4 v4, s[36:39], s66 offen offset:2048 sc1 lds
    buffer_load_dwordx4 v4, s[36:39], s66 offen offset:3072 sc1 lds
    s_add_u32 s66, s66, 8192
    s_waitcnt vmcnt(12) lgkmcnt(0)
    s_barrier
    ds_read_b128 v[160:163], v16 offset:32768
    ds_read_b128 v[164:167], v19 offset:32768
    ds_read_b128 v[168:171], v16 offset:33792
    ds_read_b128 v[172:175], v19 offset:33792
    ds_read_b128 v[176:179], v16 offset:34816
    ds_read_b128 v[180:183], v19 offset:34816
    ds_read_b128 v[184:187], v16 offset:35840
    ds_read_b128 v[188:191], v19 offset:35840
    s_add_u32 m0, s67, 0
    s_nop 0
    buffer_load_dwordx4 v4, s[36:39], s66 offen offset:0 sc1 lds
    buffer_load_dwordx4 v4, s[36:39], s66 offen offset:1024 sc1 lds
    buffer_load_dwordx4 v4, s[36:39], s66 offen offset:2048 sc1 lds
    buffer_load_dwordx4 v4, s[36:39], s66 offen offset:3072 sc1 lds
    s_add_u32 s66, s66, 8192
    v_mfma_f32_32x32x16_bf16 v[64:79], v[132:135], v[128:131], 0
    v_mfma_f32_32x32x16_bf16 v[64:79], v[140:143], v[136:139], v[64:79]
    v_mfma_f32_32x32x16_bf16 v[64:79], v[148:151], v[144:147], v[64:79]
    v_mfma_f32_32x32x16_bf16 v[64:79], v[156:159], v[152:155], v[64:79]
    s_waitcnt vmcnt(8) lgkmcnt(0)
    s_barrier
    ds_read_b128 v[128:131], v17 offset:0
    ds_read_b128 v[132:135], v20 offset:0
    ds_read_b128 v[136:139], v17 offset:1024
    ds_read_b128 v[140:143], v20 offset:1024
    ds_read_b128 v[144:147], v17 offset:2048
    ds_read_b128 v[148:151], v20 offset:2048
    ds_read_b128 v[152:155], v17 offset:3072
    ds_read_b128 v[156:159], v20 offset:3072
    s_add_u32 m0, s67, 32768
    s_nop 0
    buffer_load_dwordx4 v4, s[36:39], s66 offen offset:0 sc1 lds
    buffer_load_dwordx4 v4, s[36:39], s66 offen offset:1024 sc1 lds
    buffer_load_dwordx4 v4, s[36:39], s66 offen offset:2048 sc1 lds
    buffer_load_dwordx4 v4, s[36:39], s66 offen offset:3072 sc1 lds
    s_add_u32 s66, s66, 8192
    v_mfma_f32_32x32x16_bf16 v[64:79], v[164:167], v[160:163], v[64:79]
    v_mfma_f32_32x32x16_bf16 v[64:79], v[172:175], v[168:171], v[64:79]
    v_mfma_f32_32x32x16_bf16 v[64:79], v[180:183], v[176:179], v[64:79]
    v_mfma_f32_32x32x16_bf16 v[64:79], v[188:191], v[184:187], v[64:79]
    s_waitcnt vmcnt(8) lgkmcnt(0)
    s_barrier
    ds_read_b128 v[160:163], v17 offset:32768
    ds_read_b128 v[164:167], v20 offset:32768
    ds_read_b128 v[168:171], v17 offset:33792
    ds_read_b128 v[172:175], v20 offset:33792
    ds_read_b128 v[176:179], v17 offset:34816
    ds_read_b128 v[180:183], v20 offset:34816
    ds_read_b128 v[184:187], v17 offset:35840
    ds_read_b128 v[188:191], v20 offset:35840
    s_add_u32 m0, s67, 65536
    s_nop 0
    buffer_load_dwordx4 v4, s[36:39], s66 offen offset:0 sc1 lds
    buffer_load_dwordx4 v4, s[36:39], s66 offen offset:1024 sc1 lds
    buffer_load_dwordx4 v4, s[36:39], s66 offen offset:2048 sc1 lds
    buffer_load_dwordx4 v4, s[36:39], s66 offen offset:3072 sc1 lds
    s_add_u32 s66, s66, 8192
    v_mfma_f32_32x32x16_bf16 v[64:79], v[132:135], v[128:131], v[64:79]
    v_mfma_f32_32x32x16_bf16 v[64:79], v[140:143], v[136:139], v[64:79]
    v_mfma_f32_32x32x16_bf16 v[64:79], v[148:151], v[144:147], v[64:79]
    v_mfma_f32_32x32x16_bf16 v[64:79], v[156:159], v[152:155], v[64:79]
    s_waitcnt vmcnt(8) lgkmcnt(0)
    s_barrier
    ds_read_b128 v[128:131], v16 offset:0
    ds_read_b128 v[132:135], v19 offset:0
    ds_read_b128 v[136:139], v16 offset:1024
    ds_read_b128 v[140:143], v19 offset:1024
    ds_read_b128 v[144:147], v16 offset:2048
    ds_read_b128 v[148:151], v19 offset:2048
    ds_read_b128 v[152:155], v16 offset:3072
    ds_read_b128 v[156:159], v19 offset:3072
    s_add_u32 m0, s67, 98304
    s_nop 0
    buffer_load_dwordx4 v4, s[36:39], s66 offen offset:0 sc1 lds
    buffer_load_dwordx4 v4, s[36:39], s66 offen offset:1024 sc1 lds
    buffer_load_dwordx4 v4, s[36:39], s66 offen offset:2048 sc1 lds
    buffer_load_dwordx4 v4, s[36:39], s66 offen offset:3072 sc1 lds
    s_add_u32 s66, s66, 8192
    v_mfma_f32_32x32x16_bf16 v[64:79], v[164:167], v[160:163], v[64:79]
    v_mfma_f32_32x32x16_bf16 v[64:79], v[172:175], v[168:171], v[64:79]
    v_mfma_f32_32x32x16_bf16 v[64:79], v[180:183], v[176:179], v[64:79]
    v_mfma_f32_32x32x16_bf16 v[64:79], v[188:191], v[184:187], v[64:79]
    s_waitcnt vmcnt(8) lgkmcnt(0)
    s_barrier
    ds_read_b128 v[160:163], v16 offset:32768
    ds_read_b128 v[164:167], v19 offset:32768
    ds_read_b128 v[168:171], v16 offset:33792
    ds_read_b128 v[172:175], v19 offset:33792
    ds_read_b128 v[176:179], v16 offset:34816
    ds_read_b128 v[180:183], v19 offset:34816
    ds_read_b128 v[184:187], v16 offset:35840
    ds_read_b128 v[188:191], v19 offset:35840
    s_add_u32 m0, s67, 0
    s_nop 0
    buffer_load_dwordx4 v4, s[36:39], s66 offen offset:0 sc1 lds
    buffer_load_dwordx4 v4, s[36:39], s66 offen offset:1024 sc1 lds
    buffer_load_dwordx4 v4, s[36:39], s66 offen offset:2048 sc1 lds
    buffer_load_dwordx4 v4, s[36:39], s66 offen offset:3072 sc1 lds
    s_add_u32 s66, s66, 8192
    v_mfma_f32_32x32x16_bf16 v[64:79], v[132:135], v[128:131], v[64:79]
    v_mfma_f32_32x32x16_bf16 v[64:79], v[140:143], v[136:139], v[64:79]
    v_mfma_f32_32x32x16_bf16 v[64:79], v[148:151], v[144:147], v[64:79]
    v_mfma_f32_32x32x16_bf16 v[64:79], v[156:159], v[152:155], v[64:79]
    s_waitcnt vmcnt(8) lgkmcnt(0)
    s_barrier
    ds_read_b128 v[128:131], v17 offset:0
    ds_read_b128 v[132:135], v20 offset:0
    ds_read_b128 v[136:139], v17 offset:1024
    ds_read_b128 v[140:143], v20 offset:1024
    ds_read_b128 v[144:147], v17 offset:2048
    ds_read_b128 v[148:151], v20 offset:2048
    ds_read_b128 v[152:155], v17 offset:3072
    ds_read_b128 v[156:159], v20 offset:3072
    s_add_u32 m0, s67, 32768
    s_nop 0
    buffer_load_dwordx4 v4, s[36:39], s66 offen offset:0 sc1 lds
    buffer_load_dwordx4 v4, s[36:39], s66 offen offset:1024 sc1 lds
    buffer_load_dwordx4 v4, s[36:39], s66 offen offset:2048 sc1 lds
    buffer_load_dwordx4 v4, s[36:39], s66 offen offset:3072 sc1 lds
    s_add_u32 s66, s66, 8192
    v_mfma_f32_32x32x16_bf16 v[64:79], v[164:167], v[160:163], v[64:79]
    v_mfma_f32_32x32x16_bf16 v[64:79], v[172:175], v[168:171], v[64:79]
    v_mfma_f32_32x32x16_bf16 v[64:79], v[180:183], v[176:179], v[64:79]
    v_mfma_f32_32x32x16_bf16 v[64:79], v[188:191], v[184:187], v[64:79]
    s_waitcnt vmcnt(8) lgkmcnt(0)
    s_barrier
    ds_read_b128 v[160:163], v17 offset:32768
    ds_read_b128 v[164:167], v20 offset:32768
    ds_read_b128 v[168:171], v17 offset:33792
    ds_read_b128 v[172:175], v20 offset:33792
    ds_read_b128 v[176:179], v17 offset:34816
    ds_read_b128 v[180:183], v20 offset:34816
    ds_read_b128 v[184:187], v17 offset:35840
    ds_read_b128 v[188:191], v20 offset:35840
    s_add_u32 m0, s67, 65536
    s_nop 0
    buffer_load_dwordx4 v4, s[36:39], s66 offen offset:0 sc1 lds
    buffer_load_dwordx4 v4, s[36:39], s66 offen offset:1024 sc1 lds
    buffer_load_dwordx4 v4, s[36:39], s66 offen offset:2048 sc1 lds
    buffer_load_dwordx4 v4, s[36:39], s66 offen offset:3072 sc1 lds
    s_add_u32 s66, s66, 8192
    v_mfma_f32_32x32x16_bf16 v[64:79], v[132:135], v[128:131], v[64:79]
    v_mfma_f32_32x32x16_bf16 v[64:79], v[140:143], v[136:139], v[64:79]
    v_mfma_f32_32x32x16_bf16 v[64:79], v[148:151], v[144:147], v[64:79]
    v_mfma_f32_32x32x16_bf16 v[64:79], v[156:159], v[152:155], v[64:79]
    s_waitcnt vmcnt(8) lgkmcnt(0)
    s_barrier
    ds_read_b128 v[128:131], v16 offset:0
    ds_read_b128 v[132:135], v19 offset:0
    ds_read_b128 v[136:139], v16 offset:1024
    ds_read_b128 v[140:143], v19 offset:1024
    ds_read_b128 v[144:147], v16 offset:2048
    ds_read_b128 v[148:151], v19 offset:2048
    ds_read_b128 v[152:155], v16 offset:3072
    ds_read_b128 v[156:159], v19 offset:3072
    s_add_u32 m0, s67, 98304
    s_nop 0
    buffer_load_dwordx4 v4, s[36:39], s66 offen offset:0 sc1 lds
    buffer_load_dwordx4 v4, s[36:39], s66 offen offset:1024 sc1 lds
    buffer_load_dwordx4 v4, s[36:39], s66 offen offset:2048 sc1 lds
    buffer_load_dwordx4 v4, s[36:39], s66 offen offset:3072 sc1 lds
    s_add_u32 s66, s66, 8192
    v_mfma_f32_32x32x16_bf16 v[64:79], v[164:167], v[160:163], v[64:79]
    v_mfma_f32_32x32x16_bf16 v[64:79], v[172:175], v[168:171], v[64:79]
    v_mfma_f32_32x32x16_bf16 v[64:79], v[180:183], v[176:179], v[64:79]
    v_mfma_f32_32x32x16_bf16 v[64:79], v[188:191], v[184:187], v[64:79]
    s_waitcnt vmcnt(8) lgkmcnt(0)
    s_barrier
    ds_read_b128 v[160:163], v16 offset:32768
    ds_read_b128 v[164:167], v19 offset:32768
    ds_read_b128 v[168:171], v16 offset:33792
    ds_read_b128 v[172:175], v19 offset:33792
    ds_read_b128 v[176:179], v16 offset:34816
    ds_read_b128 v[180:183], v19 offset:34816
    ds_read_b128 v[184:187], v16 offset:35840
    ds_read_b128 v[188:191], v19 offset:35840
    s_add_u32 m0, s67, 0
    s_nop 0
    buffer_load_dwordx4 v4, s[36:39], s66 offen offset:0 sc1 lds
    buffer_load_dwordx4 v4, s[36:39], s66 offen offset:1024 sc1 lds
    buffer_load_dwordx4 v4, s[36:39], s66 offen offset:2048 sc1 lds
    buffer_load_dwordx4 v4, s[36:39], s66 offen offset:3072 sc1 lds
    s_add_u32 s66, s66, 8192
    buffer_load_dword v29, v28, s[36:39], s62 offen sc1
    v_mfma_f32_32x32x16_bf16 v[64:79], v[132:135], v[128:131], v[64:79]
    v_mfma_f32_32x32x16_bf16 v[64:79], v[140:143], v[136:139], v[64:79]
    v_mfma_f32_32x32x16_bf16 v[64:79], v[148:151], v[144:147], v[64:79]
    v_mfma_f32_32x32x16_bf16 v[64:79], v[156:159], v[152:155], v[64:79]
    s_waitcnt vmcnt(9) lgkmcnt(0)
    s_barrier
    ds_read_b128 v[128:131], v17 offset:0
    ds_read_b128 v[132:135], v20 offset:0
    ds_read_b128 v[136:139], v17 offset:1024
    ds_read_b128 v[140:143], v20 offset:1024
    ds_read_b128 v[144:147], v17 offset:2048
    ds_read_b128 v[148:151], v20 offset:2048
    ds_read_b128 v[152:155], v17 offset:3072
    ds_read_b128 v[156:159], v20 offset:3072
    s_add_u32 m0, s67, 32768
    s_nop 0
    buffer_load_dwordx4 v4, s[36:39], s66 offen offset:0 sc1 lds
    buffer_load_dwordx4 v4, s[36:39], s66 offen offset:1024 sc1 lds
    buffer_load_dwordx4 v4, s[36:39], s66 offen offset:2048 sc1 lds
    buffer_load_dwordx4 v4, s[36:39], s66 offen offset:3072 sc1 lds
    s_add_u32 s66, s66, 8192
    v_mfma_f32_32x32x16_bf16 v[64:79], v[164:167], v[160:163], v[64:79]
    v_mfma_f32_32x32x16_bf16 v[64:79], v[172:175], v[168:171], v[64:79]
    v_mfma_f32_32x32x16_bf16 v[64:79], v[180:183], v[176:179], v[64:79]
    v_mfma_f32_32x32x16_bf16 v[64:79], v[188:191], v[184:187], v[64:79]
    s_waitcnt vmcnt(9) lgkmcnt(0)
    s_barrier
    ds_read_b128 v[160:163], v17 offset:32768
    ds_read_b128 v[164:167], v20 offset:32768
    ds_read_b128 v[168:171], v17 offset:33792
    ds_read_b128 v[172:175], v20 offset:33792
    ds_read_b128 v[176:179], v17 offset:34816
    ds_read_b128 v[180:183], v20 offset:34816
    ds_read_b128 v[184:187], v17 offset:35840
    ds_read_b128 v[188:191], v20 offset:35840
    s_mov_b32 s61, 0
k2_polloA:
    s_waitcnt vmcnt(4)
    v_cmp_ne_u32 vcc, 1, v29
    s_add_u32 s61, s61, 1
    s_cmp_eq_u64 vcc, 0
    s_cbranch_scc1 k2_ookA
    buffer_load_dword v29, v28, s[36:39], s62 offen sc1
    s_waitcnt vmcnt(0)
    s_cmp_lt_u32 s61, 0x400000
    s_cbranch_scc1 k2_polloA
k2_ookA:
    s_add_u32 m0, s67, 65536
    s_nop 0
    buffer_load_dwordx4 v4, s[36:39], s66 offen offset:0 sc1 lds
    buffer_load_dwordx4 v4, s[36:39], s66 offen offset:1024 sc1 lds
    buffer_load_dwordx4 v4, s[36:39], s66 offen offset:2048 sc1 lds
    buffer_load_dwordx4 v4, s[36:39], s66 offen offset:3072 sc1 lds
    s_add_u32 s66, s66, 8192
    v_mfma_f32_32x32x16_bf16 v[64:79], v[132:135], v[128:131], v[64:79]
    v_mfma_f32_32x32x16_bf16 v[64:79], v[140:143], v[136:139], v[64:79]
    v_mfma_f32_32x32x16_bf16 v[64:79], v[148:151], v[144:147], v[64:79]
    v_mfma_f32_32x32x16_bf16 v[64:79], v[156:159], v[152:155], v[64:79]
    s_waitcnt vmcnt(9) lgkmcnt(0)
    s_barrier
    ds_read_b128 v[128:131], v16 offset:0
    ds_read_b128 v[132:135], v19 offset:0
    ds_read_b128 v[136:139], v16 offset:1024
    ds_read_b128 v[140:143], v19 offset:1024
    ds_read_b128 v[144:147], v16 offset:2048
    ds_read_b128 v[148:151], v19 offset:2048
    ds_read_b128 v[152:155], v16 offset:3072
    ds_read_b128 v[156:159], v19 offset:3072
    s_add_u32 m0, s67, 98304
    s_nop 0
    buffer_load_dwordx4 v4, s[36:39], s66 offen offset:0 sc1 lds
    buffer_load_dwordx4 v4, s[36:39], s66 offen offset:1024 sc1 lds
    buffer_load_dwordx4 v4, s[36:39], s66 offen offset:2048 sc1 lds
    buffer_load_dwordx4 v4, s[36:39], s66 offen offset:3072 sc1 lds
    s_add_u32 s66, s66, 8192
    v_mfma_f32_32x32x16_bf16 v[64:79], v[164:167], v[160:163], v[64:79]
    v_mfma_f32_32x32x16_bf16 v[64:79], v[172:175], v[168:171], v[64:79]
    v_mfma_f32_32x32x16_bf16 v[64:79], v[180:183], v[176:179], v[64:79]
    v_mfma_f32_32x32x16_bf16 v[64:79], v[188:191], v[184:187], v[64:79]
    s_waitcnt vmcnt(8) lgkmcnt(0)
    s_barrier
    ds_read_b128 v[160:163], v16 offset:32768
    ds_read_b128 v[164:167], v19 offset:32768
    ds_read_b128 v[168:171], v16 offset:33792
    ds_read_b128 v[172:175], v19 offset:33792
    ds_read_b128 v[176:179], v16 offset:34816
    ds_read_b128 v[180:183], v19 offset:34816
    ds_read_b128 v[184:187], v16 offset:35840
    ds_read_b128 v[188:191], v19 offset:35840
    s_add_u32 m0, s67, 0
    s_nop 0
    buffer_load_dwordx4 v4, s[36:39], s66 offen offset:0 sc1 lds
    buffer_load_dwordx4 v4, s[36:39], s66 offen offset:1024 sc1 lds
    buffer_load_dwordx4 v4, s[36:39], s66 offen offset:2048 sc1 lds
    buffer_load_dwordx4 v4, s[36:39], s66 offen offset:3072 sc1 lds
    s_add_u32 s66, s66, 8192
    v_mfma_f32_32x32x16_bf16 v[64:79], v[132:135], v[128:131], v[64:79]
    v_mfma_f32_32x32x16_bf16 v[64:79], v[140:143], v[136:139], v[64:79]
    v_mfma_f32_32x32x16_bf16 v[64:79], v[148:151], v[144:147], v[64:79]
    v_mfma_f32_32x32x16_bf16 v[64:79], v[156:159], v[152:155], v[64:79]
    s_waitcnt vmcnt(8) lgkmcnt(0)
    s_barrier
    ds_read_b128 v[128:131], v17 offset:0
    ds_read_b128 v[132:135], v20 offset:0
    ds_read_b128 v[136:139], v17 offset:1024
    ds_read_b128 v[140:143], v20 offset:1024
    ds_read_b128 v[144:147], v17 offset:2048
    ds_read_b128 v[148:151], v20 offset:2048
    ds_read_b128 v[152:155], v17 offset:3072
    ds_read_b128 v[156:159], v20 offset:3072
    s_add_u32 m0, s67, 32768
    s_nop 0
    buffer_load_dwordx4 v4, s[36:39], s66 offen offset:0 sc1 lds
    buffer_load_dwordx4 v4, s[36:39], s66 offen offset:1024 sc1 lds
    buffer_load_dwordx4 v4, s[36:39], s66 offen offset:2048 sc1 lds
    buffer_load_dwordx4 v4, s[36:39], s66 offen offset:3072 sc1 lds
    s_add_u32 s66, s66, 8192
    buffer_load_dwordx4 v[8:11], v6, s[4:7], 0 offen
    buffer_load_dwordx4 v[12:15], v5, s[28:31], 0 offen
    v_mfma_f32_32x32x16_bf16 v[64:79], v[164:167], v[160:163], v[64:79]
    v_mfma_f32_32x32x16_bf16 v[64:79], v[172:175], v[168:171], v[64:79]
    v_mfma_f32_32x32x16_bf16 v[64:79], v[180:183], v[176:179], v[64:79]
    v_mfma_f32_32x32x16_bf16 v[64:79], v[188:191], v[184:187], v[64:79]
    s_waitcnt vmcnt(10) lgkmcnt(0)
    s_barrier
    ds_read_b128 v[160:163], v17 offset:32768
    ds_read_b128 v[164:167], v20 offset:32768
    ds_read_b128 v[168:171], v17 offset:33792
    ds_read_b128 v[172:175], v20 offset:33792
    ds_read_b128 v[176:179], v17 offset:34816
    ds_read_b128 v[180:183], v20 offset:34816
    ds_read_b128 v[184:187], v17 offset:35840
    ds_read_b128 v[188:191], v20 offset:35840
    v_mfma_f32_32x32x16_bf16 v[80:95], v[132:135], v[128:131], 0
    v_mfma_f32_32x32x16_bf16 v[80:95], v[140:143], v[136:139], v[80:95]
    v_mfma_f32_32x32x16_bf16 v[80:95], v[148:151], v[144:147], v[80:95]
    v_mfma_f32_32x32x16_bf16 v[80:95], v[156:159], v[152:155], v[80:95]
    s_waitcnt vmcnt(6) lgkmcnt(0)
    s_barrier
    ds_read_b128 v[128:131], v16 offset:0
    ds_read_b128 v[132:135], v19 offset:0
    ds_read_b128 v[136:139], v16 offset:1024
    ds_read_b128 v[140:143], v19 offset:1024
    ds_read_b128 v[144:147], v16 offset:2048
    ds_read_b128 v[148:151], v19 offset:2048
    ds_read_b128 v[152:155], v16 offset:3072
    ds_read_b128 v[156:159], v19 offset:3072
    v_mfma_f32_32x32x16_bf16 v[80:95], v[164:167], v[160:163], v[80:95]
    v_mfma_f32_32x32x16_bf16 v[80:95], v[172:175], v[168:171], v[80:95]
    v_mfma_f32_32x32x16_bf16 v[80:95], v[180:183], v[176:179], v[80:95]
    v_mfma_f32_32x32x16_bf16 v[80:95], v[188:191], v[184:187], v[80:95]
    s_waitcnt vmcnt(2) lgkmcnt(0)
    s_barrier
    ds_read_b128 v[160:163], v16 offset:32768
    ds_read_b128 v[164:167], v19 offset:32768
    ds_read_b128 v[168:171], v16 offset:33792
    ds_read_b128 v[172:175], v19 offset:33792
    ds_read_b128 v[176:179], v16 offset:34816
    ds_read_b128 v[180:183], v19 offset:34816
    ds_read_b128 v[184:187], v16 offset:35840
    ds_read_b128 v[188:191], v19 offset:35840
    v_mfma_f32_32x32x16_bf16 v[80:95], v[132:135], v[128:131], v[80:95]
    v_mfma_f32_32x32x16_bf16 v[80:95], v[140:143], v[136:139], v[80:95]
    v_mfma_f32_32x32x16_bf16 v[80:95], v[148:151], v[144:147], v[80:95]
    v_mfma_f32_32x32x16_bf16 v[80:95], v[156:159], v[152:155], v[80:95]
    s_waitcnt lgkmcnt(6)
    v_mfma_f32_32x32x16_bf16 v[80:95], v[164:167], v[160:163], v[80:95]
    s_waitcnt lgkmcnt(4)
    v_mfma_f32_32x32x16_bf16 v[80:95], v[172:175], v[168:171], v[80:95]
    s_waitcnt lgkmcnt(2)
    v_mfma_f32_32x32x16_bf16 v[80:95], v[180:183], v[176:179], v[80:95]
    s_waitcnt lgkmcnt(0)
    v_mfma_f32_32x32x16_bf16 v[80:95], v[188:191], v[184:187], v[80:95]
    s_barrier
    s_mov_b32 s60, 0xbfb8aa3b
    ds_write_b128 v22, v[72:75] offset:0
    ds_write_b128 v22, v[76:79] offset:1024
    s_nop 7
    ds_write_b128 v22, v[88:91] offset:2048
    ds_write_b128 v22, v[92:95] offset:3072
    s_waitcnt lgkmcnt(0)
    s_barrier
    ds_read_b128 v[96:99], v23 offset:0
    ds_read_b128 v[100:103], v23 offset:1024
    ds_read_b128 v[104:107], v23 offset:2048
    ds_read_b128 v[108:111], v23 offset:3072
    s_waitcnt lgkmcnt(3)
    v_add_f32 v64, v64, v96
    v_add_f32 v65, v65, v97
    v_add_f32 v66, v66, v98
    v_add_f32 v67, v67, v99
    s_waitcnt lgkmcnt(2)
    v_add_f32 v68, v68, v100
    v_add_f32 v69, v69, v101
    v_add_f32 v70, v70, v102
    v_add_f32 v71, v71, v103
    s_waitcnt lgkmcnt(1)
    v_add_f32 v80, v80, v104
    v_add_f32 v81, v81, v105
    v_add_f32 v82, v82, v106
    v_add_f32 v83, v83, v107
    s_waitcnt lgkmcnt(0)
    v_add_f32 v84, v84, v108
    v_add_f32 v85, v85, v109
    v_add_f32 v86, v86, v110
    v_add_f32 v87, v87, v111
    v_cvt_pk_bf16_f32 v112, v64, v65
    v_lshlrev_b32 v64, 16, v112
    v_and_b32 v65, s48, v112
    v_cvt_pk_bf16_f32 v116, v66, v67
    v_lshlrev_b32 v66, 16, v116
    v_and_b32 v67, s48, v116
    v_cvt_pk_bf16_f32 v120, v68, v69
    v_lshlrev_b32 v68, 16, v120
    v_and_b32 v69, s48, v120
    v_cvt_pk_bf16_f32 v124, v70, v71
    v_lshlrev_b32 v70, 16, v124
    v_and_b32 v71, s48, v124
    s_waitcnt vmcnt(0)
    v_lshlrev_b32 v113, 16, v12
    v_and_b32 v114, s48, v12
    v_add_f32 v64, v64, v113
    v_add_f32 v65, v65, v114
    v_lshlrev_b32 v117, 16, v13
    v_and_b32 v118, s48, v13
    v_add_f32 v66, v66, v117
    v_add_f32 v67, v67, v118
    v_lshlrev_b32 v121, 16, v14
    v_and_b32 v122, s48, v14
    v_add_f32 v68, v68, v121
    v_add_f32 v69, v69, v122
    v_lshlrev_b32 v125, 16, v15
    v_and_b32 v126, s48, v15
    v_add_f32 v70, v70, v125
    v_add_f32 v71, v71, v126
    v_cvt_pk_bf16_f32 v112, v64, v65
    v_lshlrev_b32 v64, 16, v112
    v_and_b32 v65, s48, v112
    v_cvt_pk_bf16_f32 v116, v66, v67
    v_lshlrev_b32 v66, 16, v116
    v_and_b32 v67, s48, v116
    v_cvt_pk_bf16_f32 v120, v68, v69
    v_lshlrev_b32 v68, 16, v120
    v_and_b32 v69, s48, v120
    v_cvt_pk_bf16_f32 v124, v70, v71
    v_lshlrev_b32 v70, 16, v124
    v_and_b32 v71, s48, v124
    v_mul_f32 v113, s60, v64
    v_mul_f32 v114, s60, v65
    v_exp_f32 v113, v113
    v_exp_f32 v114, v114
    v_mul_f32 v117, s60, v66
    v_mul_f32 v118, s60, v67
    v_exp_f32 v117, v117
    v_exp_f32 v118, v118
    v_mul_f32 v121, s60, v68
    v_mul_f32 v122, s60, v69
    v_exp_f32 v121, v121
    v_exp_f32 v122, v122
    v_mul_f32 v125, s60, v70
    v_mul_f32 v126, s60, v71
    v_exp_f32 v125, v125
    v_exp_f32 v126, v126
    v_add_f32 v113, 1.0, v113
    v_add_f32 v114, 1.0, v114
    v_rcp_f32 v113, v113
    v_rcp_f32 v114, v114
    v_add_f32 v117, 1.0, v117
    v_add_f32 v118, 1.0, v118
    v_rcp_f32 v117, v117
    v_rcp_f32 v118, v118
    v_add_f32 v121, 1.0, v121
    v_add_f32 v122, 1.0, v122
    v_rcp_f32 v121, v121
    v_rcp_f32 v122, v122
    v_add_f32 v125, 1.0, v125
    v_add_f32 v126, 1.0, v126
    v_rcp_f32 v125, v125
    v_rcp_f32 v126, v126
    v_mul_f32 v64, v64, v113
    v_mul_f32 v65, v65, v114
    v_cvt_pk_bf16_f32 v115, v80, v81
    v_lshlrev_b32 v80, 16, v115
    v_and_b32 v81, s48, v115
    v_mul_f32 v66, v66, v117
    v_mul_f32 v67, v67, v118
    v_cvt_pk_bf16_f32 v119, v82, v83
    v_lshlrev_b32 v82, 16, v119
    v_and_b32 v83, s48, v119
    v_mul_f32 v68, v68, v121
    v_mul_f32 v69, v69, v122
    v_cvt_pk_bf16_f32 v123, v84, v85
    v_lshlrev_b32 v84, 16, v123
    v_and_b32 v85, s48, v123
    v_mul_f32 v70, v70, v125
    v_mul_f32 v71, v71, v126
    v_cvt_pk_bf16_f32 v127, v86, v87
    v_lshlrev_b32 v86, 16, v127
    v_and_b32 v87, s48, v127
    v_cvt_pk_bf16_f32 v112, v64, v65
    v_lshlrev_b32 v64, 16, v112
    v_and_b32 v65, s48, v112
    v_cvt_pk_bf16_f32 v116, v66, v67
    v_lshlrev_b32 v66, 16, v116
    v_and_b32 v67, s48, v116
    v_cvt_pk_bf16_f32 v120, v68, v69
    v_lshlrev_b32 v68, 16, v120
    v_and_b32 v69, s48, v120
    v_cvt_pk_bf16_f32 v124, v70, v71
    v_lshlrev_b32 v70, 16, v124
    v_and_b32 v71, s48, v124
    v_mul_f32 v64, v64, v80
    v_mul_f32 v65, v65, v81
    v_mul_f32 v66, v66, v82
    v_mul_f32 v67, v67, v83
    v_mul_f32 v68, v68, v84
    v_mul_f32 v69, v69, v85
    v_mul_f32 v70, v70, v86
    v_mul_f32 v71, v71, v87
    v_cvt_pk_bf16_f32 v112, v64, v65
    v_lshlrev_b32 v64, 16, v112
    v_and_b32 v65, s48, v112
    v_cvt_pk_bf16_f32 v116, v66, v67
    v_lshlrev_b32 v66, 16, v116
    v_and_b32 v67, s48, v116
    v_cvt_pk_bf16_f32 v120, v68, v69
    v_lshlrev_b32 v68, 16, v120
    v_and_b32 v69, s48, v120
    v_cvt_pk_bf16_f32 v124, v70, v71
    v_lshlrev_b32 v70, 16, v124
    v_and_b32 v71, s48, v124
    v_lshlrev_b32 v113, 16, v8
    v_and_b32 v114, s48, v8
    v_add_f32 v64, v64, v113
    v_add_f32 v65, v65, v114
    v_cvt_pk_bf16_f32 v24, v64, v65
    v_lshlrev_b32 v117, 16, v9
    v_and_b32 v118, s48, v9
    v_add_f32 v66, v66, v117
    v_add_f32 v67, v67, v118
    v_cvt_pk_bf16_f32 v25, v66, v67
    v_lshlrev_b32 v121, 16, v10
    v_and_b32 v122, s48, v10
    v_add_f32 v68, v68, v121
    v_add_f32 v69, v69, v122
    v_cvt_pk_bf16_f32 v26, v68, v69
    v_lshlrev_b32 v125, 16, v11
    v_and_b32 v126, s48, v11
    v_add_f32 v70, v70, v125
    v_add_f32 v71, v71, v126
    v_cvt_pk_bf16_f32 v27, v70, v71
    buffer_store_dwordx4 v[24:27], v6, s[16:19], 0 offen
    s_endpgm
k1_pathB:
    s_nop 15
    s_nop 3
    s_add_u32 s100, s101, 0
    s_and_b32 s100, s100, 7
    s_add_u32 m0, s54, 0
    s_lshl_b32 s50, s100, 7
    s_add_u32 s50, s50, s52
    buffer_load_dwordx4 v8, s[4:7], s50 offen lds
    s_add_u32 m0, s54, 1024
    s_lshl_b32 s50, s100, 7
    s_add_u32 s50, s50, s53
    buffer_load_dwordx4 v9, s[4:7], s50 offen lds
    s_add_u32 m0, s57, 20480
    s_mul_i32 s50, s100, 196608
    s_add_u32 s50, s50, s55
    buffer_load_dwordx4 v10, s[8:11], s50 offen lds
    s_add_u32 m0, s57, 24576
    s_mul_i32 s50, s100, 196608
    s_add_u32 s50, s50, s56
    buffer_load_dwordx4 v10, s[8:11], s50 offen lds
    s_add_u32 m0, s51, 36864
    s_mul_i32 s50, s100, 229376
    s_add_u32 s50, s50, s58
    buffer_load_dwordx4 v11, s[20:23], s50 offen lds
    s_add_u32 m0, s51, 37888
    s_mul_i32 s50, s100, 229376
    s_add_u32 s50, s50, s58
    s_add_u32 s50, s50, 28672
    buffer_load_dwordx4 v11, s[20:23], s50 offen lds
    s_add_u32 s100, s101, 1
    s_and_b32 s100, s100, 7
    s_add_u32 m0, s54, 45056
    s_lshl_b32 s50, s100, 7
    s_add_u32 s50, s50, s52
    buffer_load_dwordx4 v8, s[4:7], s50 offen lds
    s_add_u32 m0, s54, 46080
    s_lshl_b32 s50, s100, 7
    s_add_u32 s50, s50, s53
    buffer_load_dwordx4 v9, s[4:7], s50 offen lds
    s_add_u32 m0, s57, 65536
    s_mul_i32 s50, s100, 196608
    s_add_u32 s50, s50, s55
    buffer_load_dwordx4 v10, s[8:11], s50 offen lds
    s_add_u32 m0, s57, 69632
    s_mul_i32 s50, s100, 196608
    s_add_u32 s50, s50, s56
    buffer_load_dwordx4 v10, s[8:11], s50 offen lds
    s_add_u32 m0, s51, 81920
    s_mul_i32 s50, s100, 229376
    s_add_u32 s50, s50, s58
    buffer_load_dwordx4 v11, s[20:23], s50 offen lds
    s_add_u32 m0, s51, 82944
    s_mul_i32 s50, s100, 229376
    s_add_u32 s50, s50, s58
    s_add_u32 s50, s50, 28672
    buffer_load_dwordx4 v11, s[20:23], s50 offen lds
    v_and_b32 v2, 31, v1
    v_lshrrev_b32 v3, 5, v1
    v_lshlrev_b32 v4, 4, v1
    s_lshl_b32 s49, s41, 2
    s_add_u32 s49, s49, s43
    s_mov_b32 s46, 0x3f803f80
    s_mov_b32 s47, 0x3fb8aa3b
    s_mov_b32 s48, 0xffff0000
    s_waitcnt lgkmcnt(0)
    s_mov_b32 s14, 16384
    s_mov_b32 s15, 0x20000
    s_mov_b32 s18, 524288
    s_mov_b32 s19, 0x20000
    s_mov_b32 s26, 3584
    s_mov_b32 s27, 0x20000
    s_mov_b32 s30, 1835008
    s_mov_b32 s31, 0x20000
    s_mov_b32 s34, 256
    s_mov_b32 s35, 0x20000
    s_mov_b32 s38, 15728640
    s_mov_b32 s39, 0x20000
    s_lshl_b32 s60, s42, 10
    s_mov_b32 m0, 160768
    s_nop 0
    buffer_load_dwordx4 v4, s[12:15], s60 offen lds
    v_lshlrev_b32 v16, 2, v1
    s_lshl_b32 s60, s45, 6
    buffer_load_dword v144, v16, s[24:27], s60 offen
    s_lshl_b32 s60, s43, 12
    v_lshlrev_b32 v6, 7, v2
    v_add_u32 v6, s60, v6
    v_lshrrev_b32 v7, 1, v2
    v_and_b32 v7, 7, v7
    v_add_u32 v16, 0, v3
    v_xor_b32 v16, v16, v7
    v_lshlrev_b32 v16, 4, v16
    v_add_u32 v16, v16, v6
    v_add_u32 v17, 2, v3
    v_xor_b32 v17, v17, v7
    v_lshlrev_b32 v17, 4, v17
    v_add_u32 v17, v17, v6
    v_add_u32 v18, 4, v3
    v_xor_b32 v18, v18, v7
    v_lshlrev_b32 v18, 4, v18
    v_add_u32 v18, v18, v6
    v_add_u32 v19, 6, v3
    v_xor_b32 v19, v19, v7
    v_lshlrev_b32 v19, 4, v19
    v_add_u32 v19, v19, v6
    v_lshlrev_b32 v20, 9, v3
    v_and_b32 v14, 15, v1
    v_lshrrev_b32 v15, 2, v14
    v_lshlrev_b32 v15, 6, v15
    v_add_u32 v20, v20, v15
    v_and_b32 v15, 3, v1
    v_lshlrev_b32 v15, 3, v15
    v_add_u32 v20, v20, v15
    v_and_b32 v15, 16, v1
    v_lshlrev_b32 v15, 1, v15
    v_add_u32 v20, v20, v15
    v_add_u32 v20, 20480, v20
    s_lshl_b32 s60, s43, 10
    v_add_u32 v21, s60, v20
    v_lshlrev_b32 v22, 10, v3
    v_and_b32 v14, 15, v1
    v_lshrrev_b32 v15, 2, v14
    v_lshlrev_b32 v15, 7, v15
    v_add_u32 v22, v22, v15
    v_and_b32 v15, 3, v1
    v_lshlrev_b32 v15, 3, v15
    v_add_u32 v22, v22, v15
    v_and_b32 v15, 16, v1
    v_lshlrev_b32 v15, 1, v15
    v_add_u32 v22, v22, v15
    v_and_b32 v15, 8, v1
    v_lshlrev_b32 v15, 3, v15
    v_add_u32 v22, v22, v15
    v_add_u32 v22, 36864, v22
    v_xor_b32 v23, 64, v22
    s_lshl_b32 s60, s43, 11
    v_add_u32 v24, s60, v22
    v_add_u32 v25, s60, v23
    v_add_u32 v26, 45056, v16
    v_add_u32 v27, 45056, v17
    v_add_u32 v28, 45056, v18
    v_add_u32 v29, 45056, v19
    v_add_u32 v30, 45056, v20
    v_add_u32 v31, 45056, v21
    v_add_u32 v32, 45056, v22
    v_add_u32 v33, 45056, v23
    v_add_u32 v34, 45056, v24
    v_add_u32 v35, 45056, v25
    v_add_u32 v36, 90112, v16
    v_add_u32 v37, 90112, v17
    v_add_u32 v38, 90112, v18
    v_add_u32 v39, 90112, v19
    v_add_u32 v40, 90112, v20
    v_add_u32 v41, 90112, v21
    v_add_u32 v42, 90112, v22
    v_add_u32 v43, 90112, v23
    v_add_u32 v44, 90112, v24
    v_add_u32 v45, 90112, v25
    v_and_b32 v14, 15, v1
    v_lshrrev_b32 v15, 4, v1
    v_and_b32 v15, 1, v15
    v_cmp_eq_u32 vcc, v14, v15
    v_mov_b32 v14, s46
    s_nop 0
    v_cndmask_b32 v46, 0, v14, vcc
    v_cndmask_b32 v47, 0, v14, vcc
    v_cndmask_b32 v48, 0, v14, vcc
    v_cndmask_b32 v49, 0, v14, vcc
    v_mov_b32 v6, 0
    v_mov_b32 v7, 0
    v_mov_b32 v54, 0
    v_mov_b32 v55, 0
    v_mov_b32 v160, 0
    v_mov_b32 v161, 0
    v_mov_b32 v162, 0
    v_mov_b32 v163, 0
    v_mov_b32 v164, 0
    v_mov_b32 v165, 0
    v_mov_b32 v166, 0
    v_mov_b32 v167, 0
    v_mov_b32 v168, 0
    v_mov_b32 v169, 0
    v_mov_b32 v170, 0
    v_mov_b32 v171, 0
    v_mov_b32 v172, 0
    v_mov_b32 v173, 0
    v_mov_b32 v174, 0
    v_mov_b32 v175, 0
    s_waitcnt vmcnt(8) lgkmcnt(0)
    s_barrier
    s_add_u32 s100, s101, 2
    s_and_b32 s100, s100, 7
    s_add_u32 m0, s54, 90112
    s_lshl_b32 s50, s100, 7
    s_add_u32 s50, s50, s52
    buffer_load_dwordx4 v8, s[4:7], s50 offen lds
    ds_read_b128 v[176:179], v16
    ds_read_b64_tr_b16 v[192:193], v20 offset:0
    ds_read_b64_tr_b16 v[194:195], v20 offset:256
    ds_read_b64_tr_b16 v[196:197], v20 offset:4096
    ds_read_b64_tr_b16 v[198:199], v20 offset:4352
    ds_read_b64_tr_b16 v[200:201], v22 offset:0
    ds_read_b64_tr_b16 v[202:203], v22 offset:512
    ds_read_b64_tr_b16 v[204:205], v23 offset:0
    ds_read_b64_tr_b16 v[206:207], v23 offset:512
    s_add_u32 m0, s54, 91136
    s_lshl_b32 s50, s100, 7
    s_add_u32 s50, s50, s53
    buffer_load_dwordx4 v9, s[4:7], s50 offen lds
    ds_read_b128 v[180:183], v17
    ds_read_b64_tr_b16 v[208:209], v20 offset:1024
    ds_read_b64_tr_b16 v[210:211], v20 offset:1280
    ds_read_b64_tr_b16 v[212:213], v20 offset:5120
    ds_read_b64_tr_b16 v[214:215], v20 offset:5376
    ds_read_b64_tr_b16 v[216:217], v22 offset:2048
    ds_read_b64_tr_b16 v[218:219], v22 offset:2560
    ds_read_b64_tr_b16 v[220:221], v23 offset:2048
    ds_read_b64_tr_b16 v[222:223], v23 offset:2560
    s_add_u32 m0, s57, 110592
    s_mul_i32 s50, s100, 196608
    s_add_u32 s50, s50, s55
    buffer_load_dwordx4 v10, s[8:11], s50 offen lds
    s_add_u32 m0, s57, 114688
    s_mul_i32 s50, s100, 196608
    s_add_u32 s50, s50, s56
    buffer_load_dwordx4 v10, s[8:11], s50 offen lds
    s_waitcnt lgkmcnt(15)
    v_mfma_f32_32x32x16_bf16 v[64:79], v[176:179], v[192:195], 0
    ds_read_b128 v[184:187], v18
    ds_read_b64_tr_b16 v[224:225], v20 offset:2048
    s_waitcnt lgkmcnt(15)
    v_mfma_f32_32x32x16_bf16 v[80:95], v[196:199], v[176:179], 0
    ds_read_b64_tr_b16 v[226:227], v20 offset:2304
    ds_read_b64_tr_b16 v[228:229], v20 offset:6144
    s_waitcnt lgkmcnt(15)
    v_mfma_f32_32x32x16_bf16 v[96:111], v[200:203], v[176:179], 0
    ds_read_b64_tr_b16 v[230:231], v20 offset:6400
    ds_read_b64_tr_b16 v[232:233], v22 offset:4096
    s_waitcnt lgkmcnt(15)
    v_mfma_f32_32x32x16_bf16 v[112:127], v[204:207], v[176:179], 0
    ds_read_b64_tr_b16 v[234:235], v22 offset:4608
    ds_read_b64_tr_b16 v[236:237], v23 offset:4096
    ds_read_b64_tr_b16 v[238:239], v23 offset:4608
    s_cmp_lg_u32 s43, 0
    s_cbranch_scc1 k1_csB0
    v_mfma_f32_16x16x32_bf16 v[160:163], v[192:195], v[46:49], v[160:163]
    v_mfma_f32_16x16x32_bf16 v[164:167], v[196:199], v[46:49], v[164:167]
    v_mfma_f32_16x16x32_bf16 v[168:171], v[200:203], v[46:49], v[168:171]
    v_mfma_f32_16x16x32_bf16 v[172:175], v[204:207], v[46:49], v[172:175]
k1_csB0:
    s_add_u32 m0, s51, 126976
    s_mul_i32 s50, s100, 229376
    s_add_u32 s50, s50, s58
    buffer_load_dwordx4 v11, s[20:23], s50 offen lds
    s_add_u32 m0, s51, 128000
    s_mul_i32 s50, s100, 229376
    s_add_u32 s50, s50, s58
    s_add_u32 s50, s50, 28672
    buffer_load_dwordx4 v11, s[20:23], s50 offen lds
    s_waitcnt lgkmcnt(15)
    v_mfma_f32_32x32x16_bf16 v[64:79], v[180:183], v[208:211], v[64:79]
    ds_read_b128 v[188:191], v19
    ds_read_b64_tr_b16 v[240:241], v20 offset:3072
    v_lshlrev_b32 v50, 16, v180
    v_and_b32 v51, s48, v180
    v_add_f32 v6, v6, v50
    v_fmac_f32 v54, v50, v50
    v_add_f32 v7, v7, v51
    v_fmac_f32 v55, v51, v51
    s_waitcnt lgkmcnt(15)
    v_mfma_f32_32x32x16_bf16 v[80:95], v[212:215], v[180:183], v[80:95]
    ds_read_b64_tr_b16 v[242:243], v20 offset:3328
    ds_read_b64_tr_b16 v[244:245], v20 offset:7168
    v_lshlrev_b32 v52, 16, v181
    v_and_b32 v53, s48, v181
    v_add_f32 v6, v6, v52
    v_fmac_f32 v54, v52, v52
    v_add_f32 v7, v7, v53
    v_fmac_f32 v55, v53, v53
    s_waitcnt lgkmcnt(15)
    v_mfma_f32_32x32x16_bf16 v[96:111], v[216:219], v[180:183], v[96:111]
    ds_read_b64_tr_b16 v[246:247], v20 offset:7424
    ds_read_b64_tr_b16 v[248:249], v22 offset:6144
    v_lshlrev_b32 v50, 16, v182
    v_and_b32 v51, s48, v182
    v_add_f32 v6, v6, v50
    v_fmac_f32 v54, v50, v50
    v_add_f32 v7, v7, v51
    v_fmac_f32 v55, v51, v51
    s_waitcnt lgkmcnt(15)
    v_mfma_f32_32x32x16_bf16 v[112:127], v[220:223], v[180:183], v[112:127]
    ds_read_b64_tr_b16 v[250:251], v22 offset:6656
    ds_read_b64_tr_b16 v[252:253], v23 offset:6144
    ds_read_b64_tr_b16 v[254:255], v23 offset:6656
    v_lshlrev_b32 v52, 16, v183
    v_and_b32 v53, s48, v183
    v_add_f32 v6, v6, v52
    v_fmac_f32 v54, v52, v52
    v_add_f32 v7, v7, v53
    v_fmac_f32 v55, v53, v53
    s_cmp_lg_u32 s43, 1
    s_cbranch_scc1 k1_csB1
    v_mfma_f32_16x16x32_bf16 v[160:163], v[208:211], v[46:49], v[160:163]
    v_mfma_f32_16x16x32_bf16 v[164:167], v[212:215], v[46:49], v[164:167]
    v_mfma_f32_16x16x32_bf16 v[168:171], v[216:219], v[46:49], v[168:171]
    v_mfma_f32_16x16x32_bf16 v[172:175], v[220:223], v[46:49], v[172:175]
k1_csB1:
    s_waitcnt vmcnt(8) lgkmcnt(0)
    s_barrier
    s_add_u32 s100, s101, 3
    s_and_b32 s100, s100, 7
    s_add_u32 m0, s54, 0
    s_lshl_b32 s50, s100, 7
    s_add_u32 s50, s50, s52
    buffer_load_dwordx4 v8, s[4:7], s50 offen lds
    v_mfma_f32_32x32x16_bf16 v[64:79], v[184:187], v[224:227], v[64:79]
    ds_read_b128 v[176:179], v26
    ds_read_b64_tr_b16 v[192:193], v30 offset:0
    v_mfma_f32_32x32x16_bf16 v[80:95], v[228:231], v[184:187], v[80:95]
    ds_read_b64_tr_b16 v[194:195], v30 offset:256
    ds_read_b64_tr_b16 v[196:197], v30 offset:4096
    v_mfma_f32_32x32x16_bf16 v[96:111], v[232:235], v[184:187], v[96:111]
    ds_read_b64_tr_b16 v[198:199], v30 offset:4352
    ds_read_b64_tr_b16 v[200:201], v32 offset:0
    v_mfma_f32_32x32x16_bf16 v[112:127], v[236:239], v[184:187], v[112:127]
    ds_read_b64_tr_b16 v[202:203], v32 offset:512
    ds_read_b64_tr_b16 v[204:205], v33 offset:0
    ds_read_b64_tr_b16 v[206:207], v33 offset:512
    s_cmp_lg_u32 s43, 2
    s_cbranch_scc1 k1_csB2
    v_mfma_f32_16x16x32_bf16 v[160:163], v[224:227], v[46:49], v[160:163]
    v_mfma_f32_16x16x32_bf16 v[164:167], v[228:231], v[46:49], v[164:167]
    v_mfma_f32_16x16x32_bf16 v[168:171], v[232:235], v[46:49], v[168:171]
    v_mfma_f32_16x16x32_bf16 v[172:175], v[236:239], v[46:49], v[172:175]
k1_csB2:
    s_add_u32 m0, s54, 1024
    s_lshl_b32 s50, s100, 7
    s_add_u32 s50, s50, s53
    buffer_load_dwordx4 v9, s[4:7], s50 offen lds
    v_mfma_f32_32x32x16_bf16 v[64:79], v[188:191], v[240:243], v[64:79]
    ds_read_b128 v[180:183], v27
    ds_read_b64_tr_b16 v[208:209], v30 offset:1024
    v_lshlrev_b32 v50, 16, v188
    v_and_b32 v51, s48, v188
    v_add_f32 v6, v6, v50
    v_fmac_f32 v54, v50, v50
    v_add_f32 v7, v7, v51
    v_fmac_f32 v55, v51, v51
    v_mfma_f32_32x32x16_bf16 v[80:95], v[244:247], v[188:191], v[80:95]
    ds_read_b64_tr_b16 v[210:211], v30 offset:1280
    ds_read_b64_tr_b16 v[212:213], v30 offset:5120
    v_lshlrev_b32 v52, 16, v189
    v_and_b32 v53, s48, v189
    v_add_f32 v6, v6, v52
    v_fmac_f32 v54, v52, v52
    v_add_f32 v7, v7, v53
    v_fmac_f32 v55, v53, v53
    v_mfma_f32_32x32x16_bf16 v[96:111], v[248:251], v[188:191], v[96:111]
    ds_read_b64_tr_b16 v[214:215], v30 offset:5376
    ds_read_b64_tr_b16 v[216:217], v32 offset:2048
    v_lshlrev_b32 v50, 16, v190
    v_and_b32 v51, s48, v190
    v_add_f32 v6, v6, v50
    v_fmac_f32 v54, v50, v50
    v_add_f32 v7, v7, v51
    v_fmac_f32 v55, v51, v51
    v_mfma_f32_32x32x16_bf16 v[112:127], v[252:255], v[188:191], v[112:127]
    ds_read_b64_tr_b16 v[218:219], v32 offset:2560
    ds_read_b64_tr_b16 v[220:221], v33 offset:2048
    ds_read_b64_tr_b16 v[222:223], v33 offset:2560
    v_lshlrev_b32 v52, 16, v191
    v_and_b32 v53, s48, v191
    v_add_f32 v6, v6, v52
    v_fmac_f32 v54, v52, v52
    v_add_f32 v7, v7, v53
    v_fmac_f32 v55, v53, v53
    s_cmp_lg_u32 s43, 3
    s_cbranch_scc1 k1_csB3
    v_mfma_f32_16x16x32_bf16 v[160:163], v[240:243], v[46:49], v[160:163]
    v_mfma_f32_16x16x32_bf16 v[164:167], v[244:247], v[46:49], v[164:167]
    v_mfma_f32_16x16x32_bf16 v[168:171], v[248:251], v[46:49], v[168:171]
    v_mfma_f32_16x16x32_bf16 v[172:175], v[252:255], v[46:49], v[172:175]
k1_csB3:
    s_add_u32 m0, s57, 20480
    s_mul_i32 s50, s100, 196608
    s_add_u32 s50, s50, s55
    buffer_load_dwordx4 v10, s[8:11], s50 offen lds
    s_add_u32 m0, s57, 24576
    s_mul_i32 s50, s100, 196608
    s_add_u32 s50, s50, s56
    buffer_load_dwordx4 v10, s[8:11], s50 offen lds
    s_waitcnt lgkmcnt(15)
    v_mfma_f32_32x32x16_bf16 v[64:79], v[176:179], v[192:195], v[64:79]
    ds_read_b128 v[184:187], v28
    ds_read_b64_tr_b16 v[224:225], v30 offset:2048
    s_waitcnt lgkmcnt(15)
    v_mfma_f32_32x32x16_bf16 v[80:95], v[196:199], v[176:179], v[80:95]
    ds_read_b64_tr_b16 v[226:227], v30 offset:2304
    ds_read_b64_tr_b16 v[228:229], v30 offset:6144
    s_waitcnt lgkmcnt(15)
    v_mfma_f32_32x32x16_bf16 v[96:111], v[200:203], v[176:179], v[96:111]
    ds_read_b64_tr_b16 v[230:231], v30 offset:6400
    ds_read_b64_tr_b16 v[232:233], v32 offset:4096
    s_waitcnt lgkmcnt(15)
    v_mfma_f32_32x32x16_bf16 v[112:127], v[204:207], v[176:179], v[112:127]
    ds_read_b64_tr_b16 v[234:235], v32 offset:4608
    ds_read_b64_tr_b16 v[236:237], v33 offset:4096
    ds_read_b64_tr_b16 v[238:239], v33 offset:4608
    s_cmp_lg_u32 s43, 0
    s_cbranch_scc1 k1_csB4
    v_mfma_f32_16x16x32_bf16 v[160:163], v[192:195], v[46:49], v[160:163]
    v_mfma_f32_16x16x32_bf16 v[164:167], v[196:199], v[46:49], v[164:167]
    v_mfma_f32_16x16x32_bf16 v[168:171], v[200:203], v[46:49], v[168:171]
    v_mfma_f32_16x16x32_bf16 v[172:175], v[204:207], v[46:49], v[172:175]
k1_csB4:
    s_add_u32 m0, s51, 36864
    s_mul_i32 s50, s100, 229376
    s_add_u32 s50, s50, s58
    buffer_load_dwordx4 v11, s[20:23], s50 offen lds
    s_add_u32 m0, s51, 37888
    s_mul_i32 s50, s100, 229376
    s_add_u32 s50, s50, s58
    s_add_u32 s50, s50, 28672
    buffer_load_dwordx4 v11, s[20:23], s50 offen lds
    s_waitcnt lgkmcnt(15)
    v_mfma_f32_32x32x16_bf16 v[64:79], v[180:183], v[208:211], v[64:79]
    ds_read_b128 v[188:191], v29
    ds_read_b64_tr_b16 v[240:241], v30 offset:3072
    v_lshlrev_b32 v50, 16, v180
    v_and_b32 v51, s48, v180
    v_add_f32 v6, v6, v50
    v_fmac_f32 v54, v50, v50
    v_add_f32 v7, v7, v51
    v_fmac_f32 v55, v51, v51
    s_waitcnt lgkmcnt(15)
    v_mfma_f32_32x32x16_bf16 v[80:95], v[212:215], v[180:183], v[80:95]
    ds_read_b64_tr_b16 v[242:243], v30 offset:3328
    ds_read_b64_tr_b16 v[244:245], v30 offset:7168
    v_lshlrev_b32 v52, 16, v181
    v_and_b32 v53, s48, v181
    v_add_f32 v6, v6, v52
    v_fmac_f32 v54, v52, v52
    v_add_f32 v7, v7, v53
    v_fmac_f32 v55, v53, v53
    s_waitcnt lgkmcnt(15)
    v_mfma_f32_32x32x16_bf16 v[96:111], v[216:219], v[180:183], v[96:111]
    ds_read_b64_tr_b16 v[246:247], v30 offset:7424
    ds_read_b64_tr_b16 v[248:249], v32 offset:6144
    v_lshlrev_b32 v50, 16, v182
    v_and_b32 v51, s48, v182
    v_add_f32 v6, v6, v50
    v_fmac_f32 v54, v50, v50
    v_add_f32 v7, v7, v51
    v_fmac_f32 v55, v51, v51
    s_waitcnt lgkmcnt(15)
    v_mfma_f32_32x32x16_bf16 v[112:127], v[220:223], v[180:183], v[112:127]
    ds_read_b64_tr_b16 v[250:251], v32 offset:6656
    ds_read_b64_tr_b16 v[252:253], v33 offset:6144
    ds_read_b64_tr_b16 v[254:255], v33 offset:6656
    v_lshlrev_b32 v52, 16, v183
    v_and_b32 v53, s48, v183
    v_add_f32 v6, v6, v52
    v_fmac_f32 v54, v52, v52
    v_add_f32 v7, v7, v53
    v_fmac_f32 v55, v53, v53
    s_cmp_lg_u32 s43, 1
    s_cbranch_scc1 k1_csB5
    v_mfma_f32_16x16x32_bf16 v[160:163], v[208:211], v[46:49], v[160:163]
    v_mfma_f32_16x16x32_bf16 v[164:167], v[212:215], v[46:49], v[164:167]
    v_mfma_f32_16x16x32_bf16 v[168:171], v[216:219], v[46:49], v[168:171]
    v_mfma_f32_16x16x32_bf16 v[172:175], v[220:223], v[46:49], v[172:175]
k1_csB5:
    s_waitcnt vmcnt(6) lgkmcnt(0)
    s_barrier
    s_add_u32 s100, s101, 4
    s_and_b32 s100, s100, 7
    s_add_u32 m0, s54, 45056
    s_lshl_b32 s50, s100, 7
    s_add_u32 s50, s50, s52
    buffer_load_dwordx4 v8, s[4:7], s50 offen lds
    v_mfma_f32_32x32x16_bf16 v[64:79], v[184:187], v[224:227], v[64:79]
    ds_read_b128 v[176:179], v36
    ds_read_b64_tr_b16 v[192:193], v40 offset:0
    v_mfma_f32_32x32x16_bf16 v[80:95], v[228:231], v[184:187], v[80:95]
    ds_read_b64_tr_b16 v[194:195], v40 offset:256
    ds_read_b64_tr_b16 v[196:197], v40 offset:4096
    v_mfma_f32_32x32x16_bf16 v[96:111], v[232:235], v[184:187], v[96:111]
    ds_read_b64_tr_b16 v[198:199], v40 offset:4352
    ds_read_b64_tr_b16 v[200:201], v42 offset:0
    v_mfma_f32_32x32x16_bf16 v[112:127], v[236:239], v[184:187], v[112:127]
    ds_read_b64_tr_b16 v[202:203], v42 offset:512
    ds_read_b64_tr_b16 v[204:205], v43 offset:0
    ds_read_b64_tr_b16 v[206:207], v43 offset:512
    s_cmp_lg_u32 s43, 2
    s_cbranch_scc1 k1_csB6
    v_mfma_f32_16x16x32_bf16 v[160:163], v[224:227], v[46:49], v[160:163]
    v_mfma_f32_16x16x32_bf16 v[164:167], v[228:231], v[46:49], v[164:167]
    v_mfma_f32_16x16x32_bf16 v[168:171], v[232:235], v[46:49], v[168:171]
    v_mfma_f32_16x16x32_bf16 v[172:175], v[236:239], v[46:49], v[172:175]
k1_csB6:
    s_add_u32 m0, s54, 46080
    s_lshl_b32 s50, s100, 7
    s_add_u32 s50, s50, s53
    buffer_load_dwordx4 v9, s[4:7], s50 offen lds
    v_mfma_f32_32x32x16_bf16 v[64:79], v[188:191], v[240:243], v[64:79]
    ds_read_b128 v[180:183], v37
    ds_read_b64_tr_b16 v[208:209], v40 offset:1024
    v_lshlrev_b32 v50, 16, v188
    v_and_b32 v51, s48, v188
    v_add_f32 v6, v6, v50
    v_fmac_f32 v54, v50, v50
    v_add_f32 v7, v7, v51
    v_fmac_f32 v55, v51, v51
    v_mfma_f32_32x32x16_bf16 v[80:95], v[244:247], v[188:191], v[80:95]
    ds_read_b64_tr_b16 v[210:211], v40 offset:1280
    ds_read_b64_tr_b16 v[212:213], v40 offset:5120
    v_lshlrev_b32 v52, 16, v189
    v_and_b32 v53, s48, v189
    v_add_f32 v6, v6, v52
    v_fmac_f32 v54, v52, v52
    v_add_f32 v7, v7, v53
    v_fmac_f32 v55, v53, v53
    v_mfma_f32_32x32x16_bf16 v[96:111], v[248:251], v[188:191], v[96:111]
    ds_read_b64_tr_b16 v[214:215], v40 offset:5376
    ds_read_b64_tr_b16 v[216:217], v42 offset:2048
    v_lshlrev_b32 v50, 16, v190
    v_and_b32 v51, s48, v190
    v_add_f32 v6, v6, v50
    v_fmac_f32 v54, v50, v50
    v_add_f32 v7, v7, v51
    v_fmac_f32 v55, v51, v51
    v_mfma_f32_32x32x16_bf16 v[112:127], v[252:255], v[188:191], v[112:127]
    ds_read_b64_tr_b16 v[218:219], v42 offset:2560
    ds_read_b64_tr_b16 v[220:221], v43 offset:2048
    ds_read_b64_tr_b16 v[222:223], v43 offset:2560
    v_lshlrev_b32 v52, 16, v191
    v_and_b32 v53, s48, v191
    v_add_f32 v6, v6, v52
    v_fmac_f32 v54, v52, v52
    v_add_f32 v7, v7, v53
    v_fmac_f32 v55, v53, v53
    s_cmp_lg_u32 s43, 3
    s_cbranch_scc1 k1_csB7
    v_mfma_f32_16x16x32_bf16 v[160:163], v[240:243], v[46:49], v[160:163]
    v_mfma_f32_16x16x32_bf16 v[164:167], v[244:247], v[46:49], v[164:167]
    v_mfma_f32_16x16x32_bf16 v[168:171], v[248:251], v[46:49], v[168:171]
    v_mfma_f32_16x16x32_bf16 v[172:175], v[252:255], v[46:49], v[172:175]
k1_csB7:
    s_add_u32 m0, s57, 65536
    s_mul_i32 s50, s100, 196608
    s_add_u32 s50, s50, s55
    buffer_load_dwordx4 v10, s[8:11], s50 offen lds
    s_add_u32 m0, s57, 69632
    s_mul_i32 s50, s100, 196608
    s_add_u32 s50, s50, s56
    buffer_load_dwordx4 v10, s[8:11], s50 offen lds
    s_waitcnt lgkmcnt(15)
    v_mfma_f32_32x32x16_bf16 v[64:79], v[176:179], v[192:195], v[64:79]
    ds_read_b128 v[184:187], v38
    ds_read_b64_tr_b16 v[224:225], v40 offset:2048
    s_waitcnt lgkmcnt(15)
    v_mfma_f32_32x32x16_bf16 v[80:95], v[196:199], v[176:179], v[80:95]
    ds_read_b64_tr_b16 v[226:227], v40 offset:2304
    ds_read_b64_tr_b16 v[228:229], v40 offset:6144
    s_waitcnt lgkmcnt(15)
    v_mfma_f32_32x32x16_bf16 v[96:111], v[200:203], v[176:179], v[96:111]
    ds_read_b64_tr_b16 v[230:231], v40 offset:6400
    ds_read_b64_tr_b16 v[232:233], v42 offset:4096
    s_waitcnt lgkmcnt(15)
    v_mfma_f32_32x32x16_bf16 v[112:127], v[204:207], v[176:179], v[112:127]
    ds_read_b64_tr_b16 v[234:235], v42 offset:4608
    ds_read_b64_tr_b16 v[236:237], v43 offset:4096
    ds_read_b64_tr_b16 v[238:239], v43 offset:4608
    s_cmp_lg_u32 s43, 0
    s_cbranch_scc1 k1_csB8
    v_mfma_f32_16x16x32_bf16 v[160:163], v[192:195], v[46:49], v[160:163]
    v_mfma_f32_16x16x32_bf16 v[164:167], v[196:199], v[46:49], v[164:167]
    v_mfma_f32_16x16x32_bf16 v[168:171], v[200:203], v[46:49], v[168:171]
    v_mfma_f32_16x16x32_bf16 v[172:175], v[204:207], v[46:49], v[172:175]
k1_csB8:
    s_add_u32 m0, s51, 81920
    s_mul_i32 s50, s100, 229376
    s_add_u32 s50, s50, s58
    buffer_load_dwordx4 v11, s[20:23], s50 offen lds
    s_add_u32 m0, s51, 82944
    s_mul_i32 s50, s100, 229376
    s_add_u32 s50, s50, s58
    s_add_u32 s50, s50, 28672
    buffer_load_dwordx4 v11, s[20:23], s50 offen lds
    s_waitcnt lgkmcnt(15)
    v_mfma_f32_32x32x16_bf16 v[64:79], v[180:183], v[208:211], v[64:79]
    ds_read_b128 v[188:191], v39
    ds_read_b64_tr_b16 v[240:241], v40 offset:3072
    v_lshlrev_b32 v50, 16, v180
    v_and_b32 v51, s48, v180
    v_add_f32 v6, v6, v50
    v_fmac_f32 v54, v50, v50
    v_add_f32 v7, v7, v51
    v_fmac_f32 v55, v51, v51
    s_waitcnt lgkmcnt(15)
    v_mfma_f32_32x32x16_bf16 v[80:95], v[212:215], v[180:183], v[80:95]
    ds_read_b64_tr_b16 v[242:243], v40 offset:3328
    ds_read_b64_tr_b16 v[244:245], v40 offset:7168
    v_lshlrev_b32 v52, 16, v181
    v_and_b32 v53, s48, v181
    v_add_f32 v6, v6, v52
    v_fmac_f32 v54, v52, v52
    v_add_f32 v7, v7, v53
    v_fmac_f32 v55, v53, v53
    s_waitcnt lgkmcnt(15)
    v_mfma_f32_32x32x16_bf16 v[96:111], v[216:219], v[180:183], v[96:111]
    ds_read_b64_tr_b16 v[246:247], v40 offset:7424
    ds_read_b64_tr_b16 v[248:249], v42 offset:6144
    v_lshlrev_b32 v50, 16, v182
    v_and_b32 v51, s48, v182
    v_add_f32 v6, v6, v50
    v_fmac_f32 v54, v50, v50
    v_add_f32 v7, v7, v51
    v_fmac_f32 v55, v51, v51
    s_waitcnt lgkmcnt(15)
    v_mfma_f32_32x32x16_bf16 v[112:127], v[220:223], v[180:183], v[112:127]
    ds_read_b64_tr_b16 v[250:251], v42 offset:6656
    ds_read_b64_tr_b16 v[252:253], v43 offset:6144
    ds_read_b64_tr_b16 v[254:255], v43 offset:6656
    v_lshlrev_b32 v52, 16, v183
    v_and_b32 v53, s48, v183
    v_add_f32 v6, v6, v52
    v_fmac_f32 v54, v52, v52
    v_add_f32 v7, v7, v53
    v_fmac_f32 v55, v53, v53
    s_cmp_lg_u32 s43, 1
    s_cbranch_scc1 k1_csB9
    v_mfma_f32_16x16x32_bf16 v[160:163], v[208:211], v[46:49], v[160:163]
    v_mfma_f32_16x16x32_bf16 v[164:167], v[212:215], v[46:49], v[164:167]
    v_mfma_f32_16x16x32_bf16 v[168:171], v[216:219], v[46:49], v[168:171]
    v_mfma_f32_16x16x32_bf16 v[172:175], v[220:223], v[46:49], v[172:175]
k1_csB9:
    s_waitcnt vmcnt(6) lgkmcnt(0)
    s_barrier
    s_add_u32 s100, s101, 5
    s_and_b32 s100, s100, 7
    s_add_u32 m0, s54, 90112
    s_lshl_b32 s50, s100, 7
    s_add_u32 s50, s50, s52
    buffer_load_dwordx4 v8, s[4:7], s50 offen lds
    v_mfma_f32_32x32x16_bf16 v[64:79], v[184:187], v[224:227], v[64:79]
    ds_read_b128 v[176:179], v16
    ds_read_b64_tr_b16 v[192:193], v20 offset:0
    v_mfma_f32_32x32x16_bf16 v[80:95], v[228:231], v[184:187], v[80:95]
    ds_read_b64_tr_b16 v[194:195], v20 offset:256
    ds_read_b64_tr_b16 v[196:197], v20 offset:4096
    v_mfma_f32_32x32x16_bf16 v[96:111], v[232:235], v[184:187], v[96:111]
    ds_read_b64_tr_b16 v[198:199], v20 offset:4352
    ds_read_b64_tr_b16 v[200:201], v22 offset:0
    v_mfma_f32_32x32x16_bf16 v[112:127], v[236:239], v[184:187], v[112:127]
    ds_read_b64_tr_b16 v[202:203], v22 offset:512
    ds_read_b64_tr_b16 v[204:205], v23 offset:0
    ds_read_b64_tr_b16 v[206:207], v23 offset:512
    s_cmp_lg_u32 s43, 2
    s_cbranch_scc1 k1_csB10
    v_mfma_f32_16x16x32_bf16 v[160:163], v[224:227], v[46:49], v[160:163]
    v_mfma_f32_16x16x32_bf16 v[164:167], v[228:231], v[46:49], v[164:167]
    v_mfma_f32_16x16x32_bf16 v[168:171], v[232:235], v[46:49], v[168:171]
    v_mfma_f32_16x16x32_bf16 v[172:175], v[236:239], v[46:49], v[172:175]
k1_csB10:
    s_add_u32 m0, s54, 91136
    s_lshl_b32 s50, s100, 7
    s_add_u32 s50, s50, s53
    buffer_load_dwordx4 v9, s[4:7], s50 offen lds
    v_mfma_f32_32x32x16_bf16 v[64:79], v[188:191], v[240:243], v[64:79]
    ds_read_b128 v[180:183], v17
    ds_read_b64_tr_b16 v[208:209], v20 offset:1024
    v_lshlrev_b32 v50, 16, v188
    v_and_b32 v51, s48, v188
    v_add_f32 v6, v6, v50
    v_fmac_f32 v54, v50, v50
    v_add_f32 v7, v7, v51
    v_fmac_f32 v55, v51, v51
    v_mfma_f32_32x32x16_bf16 v[80:95], v[244:247], v[188:191], v[80:95]
    ds_read_b64_tr_b16 v[210:211], v20 offset:1280
    ds_read_b64_tr_b16 v[212:213], v20 offset:5120
    v_lshlrev_b32 v52, 16, v189
    v_and_b32 v53, s48, v189
    v_add_f32 v6, v6, v52
    v_fmac_f32 v54, v52, v52
    v_add_f32 v7, v7, v53
    v_fmac_f32 v55, v53, v53
    v_mfma_f32_32x32x16_bf16 v[96:111], v[248:251], v[188:191], v[96:111]
    ds_read_b64_tr_b16 v[214:215], v20 offset:5376
    ds_read_b64_tr_b16 v[216:217], v22 offset:2048
    v_lshlrev_b32 v50, 16, v190
    v_and_b32 v51, s48, v190
    v_add_f32 v6, v6, v50
    v_fmac_f32 v54, v50, v50
    v_add_f32 v7, v7, v51
    v_fmac_f32 v55, v51, v51
    v_mfma_f32_32x32x16_bf16 v[112:127], v[252:255], v[188:191], v[112:127]
    ds_read_b64_tr_b16 v[218:219], v22 offset:2560
    ds_read_b64_tr_b16 v[220:221], v23 offset:2048
    ds_read_b64_tr_b16 v[222:223], v23 offset:2560
    v_lshlrev_b32 v52, 16, v191
    v_and_b32 v53, s48, v191
    v_add_f32 v6, v6, v52
    v_fmac_f32 v54, v52, v52
    v_add_f32 v7, v7, v53
    v_fmac_f32 v55, v53, v53
    s_cmp_lg_u32 s43, 3
    s_cbranch_scc1 k1_csB11
    v_mfma_f32_16x16x32_bf16 v[160:163], v[240:243], v[46:49], v[160:163]
    v_mfma_f32_16x16x32_bf16 v[164:167], v[244:247], v[46:49], v[164:167]
    v_mfma_f32_16x16x32_bf16 v[168:171], v[248:251], v[46:49], v[168:171]
    v_mfma_f32_16x16x32_bf16 v[172:175], v[252:255], v[46:49], v[172:175]
k1_csB11:
    s_add_u32 m0, s57, 110592
    s_mul_i32 s50, s100, 196608
    s_add_u32 s50, s50, s55
    buffer_load_dwordx4 v10, s[8:11], s50 offen lds
    s_add_u32 m0, s57, 114688
    s_mul_i32 s50, s100, 196608
    s_add_u32 s50, s50, s56
    buffer_load_dwordx4 v10, s[8:11], s50 offen lds
    s_waitcnt lgkmcnt(15)
    v_mfma_f32_32x32x16_bf16 v[64:79], v[176:179], v[192:195], v[64:79]
    ds_read_b128 v[184:187], v18
    ds_read_b64_tr_b16 v[224:225], v20 offset:2048
    s_waitcnt lgkmcnt(15)
    v_mfma_f32_32x32x16_bf16 v[80:95], v[196:199], v[176:179], v[80:95]
    ds_read_b64_tr_b16 v[226:227], v20 offset:2304
    ds_read_b64_tr_b16 v[228:229], v20 offset:6144
    s_waitcnt lgkmcnt(15)
    v_mfma_f32_32x32x16_bf16 v[96:111], v[200:203], v[176:179], v[96:111]
    ds_read_b64_tr_b16 v[230:231], v20 offset:6400
    ds_read_b64_tr_b16 v[232:233], v22 offset:4096
    s_waitcnt lgkmcnt(15)
    v_mfma_f32_32x32x16_bf16 v[112:127], v[204:207], v[176:179], v[112:127]
    ds_read_b64_tr_b16 v[234:235], v22 offset:4608
    ds_read_b64_tr_b16 v[236:237], v23 offset:4096
    ds_read_b64_tr_b16 v[238:239], v23 offset:4608
    s_cmp_lg_u32 s43, 0
    s_cbranch_scc1 k1_csB12
    v_mfma_f32_16x16x32_bf16 v[160:163], v[192:195], v[46:49], v[160:163]
    v_mfma_f32_16x16x32_bf16 v[164:167], v[196:199], v[46:49], v[164:167]
    v_mfma_f32_16x16x32_bf16 v[168:171], v[200:203], v[46:49], v[168:171]
    v_mfma_f32_16x16x32_bf16 v[172:175], v[204:207], v[46:49], v[172:175]
k1_csB12:
    s_add_u32 m0, s51, 126976
    s_mul_i32 s50, s100, 229376
    s_add_u32 s50, s50, s58
    buffer_load_dwordx4 v11, s[20:23], s50 offen lds
    s_add_u32 m0, s51, 128000
    s_mul_i32 s50, s100, 229376
    s_add_u32 s50, s50, s58
    s_add_u32 s50, s50, 28672
    buffer_load_dwordx4 v11, s[20:23], s50 offen lds
    s_waitcnt lgkmcnt(15)
    v_mfma_f32_32x32x16_bf16 v[64:79], v[180:183], v[208:211], v[64:79]
    ds_read_b128 v[188:191], v19
    ds_read_b64_tr_b16 v[240:241], v20 offset:3072
    v_lshlrev_b32 v50, 16, v180
    v_and_b32 v51, s48, v180
    v_add_f32 v6, v6, v50
    v_fmac_f32 v54, v50, v50
    v_add_f32 v7, v7, v51
    v_fmac_f32 v55, v51, v51
    s_waitcnt lgkmcnt(15)
    v_mfma_f32_32x32x16_bf16 v[80:95], v[212:215], v[180:183], v[80:95]
    ds_read_b64_tr_b16 v[242:243], v20 offset:3328
    ds_read_b64_tr_b16 v[244:245], v20 offset:7168
    v_lshlrev_b32 v52, 16, v181
    v_and_b32 v53, s48, v181
    v_add_f32 v6, v6, v52
    v_fmac_f32 v54, v52, v52
    v_add_f32 v7, v7, v53
    v_fmac_f32 v55, v53, v53
    s_waitcnt lgkmcnt(15)
    v_mfma_f32_32x32x16_bf16 v[96:111], v[216:219], v[180:183], v[96:111]
    ds_read_b64_tr_b16 v[246:247], v20 offset:7424
    ds_read_b64_tr_b16 v[248:249], v22 offset:6144
    v_lshlrev_b32 v50, 16, v182
    v_and_b32 v51, s48, v182
    v_add_f32 v6, v6, v50
    v_fmac_f32 v54, v50, v50
    v_add_f32 v7, v7, v51
    v_fmac_f32 v55, v51, v51
    s_waitcnt lgkmcnt(15)
    v_mfma_f32_32x32x16_bf16 v[112:127], v[220:223], v[180:183], v[112:127]
    ds_read_b64_tr_b16 v[250:251], v22 offset:6656
    ds_read_b64_tr_b16 v[252:253], v23 offset:6144
    ds_read_b64_tr_b16 v[254:255], v23 offset:6656
    v_lshlrev_b32 v52, 16, v183
    v_and_b32 v53, s48, v183
    v_add_f32 v6, v6, v52
    v_fmac_f32 v54, v52, v52
    v_add_f32 v7, v7, v53
    v_fmac_f32 v55, v53, v53
    s_cmp_lg_u32 s43, 1
    s_cbranch_scc1 k1_csB13
    v_mfma_f32_16x16x32_bf16 v[160:163], v[208:211], v[46:49], v[160:163]
    v_mfma_f32_16x16x32_bf16 v[164:167], v[212:215], v[46:49], v[164:167]
    v_mfma_f32_16x16x32_bf16 v[168:171], v[216:219], v[46:49], v[168:171]
    v_mfma_f32_16x16x32_bf16 v[172:175], v[220:223], v[46:49], v[172:175]
k1_csB13:
    v_and_b32 v14, 1, v1
    v_lshlrev_b32 v14, 9, v14
    v_lshlrev_b32 v15, 7, v3
    v_add_u32 v14, v14, v15
    v_and_b32 v15, 15, v1
    v_lshrrev_b32 v15, 2, v15
    v_lshlrev_b32 v15, 5, v15
    v_add_u32 v14, v14, v15
    v_and_b32 v15, 16, v1
    v_add_u32 v14, v14, v15
    v_and_b32 v15, 2, v1
    v_lshlrev_b32 v15, 2, v15
    v_add_u32 v14, v14, v15
    v_add_u32 v14, 160768, v14
    ds_read_b64_tr_b16 v[60:61], v14
    ds_read_b64_tr_b16 v[62:63], v14 offset:256
    v_lshrrev_b32 v13, 2, v2
    v_and_b32 v13, 1, v13
    v_cmp_eq_u32 vcc, 0, v13
    s_waitcnt lgkmcnt(1)
    s_nop 0
    v_cndmask_b32 v56, 0, v60, vcc
    v_cndmask_b32 v57, 0, v61, vcc
    s_waitcnt lgkmcnt(0)
    v_cndmask_b32 v58, 0, v62, vcc
    v_cndmask_b32 v59, 0, v63, vcc
    v_cndmask_b32 v60, v60, 0, vcc
    v_cndmask_b32 v61, v61, 0, vcc
    v_cndmask_b32 v62, v62, 0, vcc
    v_cndmask_b32 v63, v63, 0, vcc
    v_lshlrev_b32 v146, 16, v144
    v_and_b32 v147, s48, v144
    v_lshlrev_b32 v145, 3, v1
    v_add_u32 v145, 138240, v145
    ds_write_b64 v145, v[146:147]
    s_waitcnt vmcnt(6) lgkmcnt(0)
    s_barrier
    s_add_u32 s100, s101, 6
    s_and_b32 s100, s100, 7
    s_add_u32 m0, s54, 0
    s_lshl_b32 s50, s100, 7
    s_add_u32 s50, s50, s52
    buffer_load_dwordx4 v8, s[4:7], s50 offen lds
    v_mfma_f32_32x32x16_bf16 v[64:79], v[184:187], v[224:227], v[64:79]
    ds_read_b128 v[176:179], v26
    ds_read_b64_tr_b16 v[192:193], v30 offset:0
    v_mfma_f32_32x32x16_bf16 v[80:95], v[228:231], v[184:187], v[80:95]
    ds_read_b64_tr_b16 v[194:195], v30 offset:256
    ds_read_b64_tr_b16 v[196:197], v30 offset:4096
    v_mfma_f32_32x32x16_bf16 v[96:111], v[232:235], v[184:187], v[96:111]
    ds_read_b64_tr_b16 v[198:199], v30 offset:4352
    ds_read_b64_tr_b16 v[200:201], v32 offset:0
    v_mfma_f32_32x32x16_bf16 v[112:127], v[236:239], v[184:187], v[112:127]
    ds_read_b64_tr_b16 v[202:203], v32 offset:512
    ds_read_b64_tr_b16 v[204:205], v33 offset:0
    ds_read_b64_tr_b16 v[206:207], v33 offset:512
    s_cmp_lg_u32 s43, 2
    s_cbranch_scc1 k1_csB14
    v_mfma_f32_16x16x32_bf16 v[160:163], v[224:227], v[46:49], v[160:163]
    v_mfma_f32_16x16x32_bf16 v[164:167], v[228:231], v[46:49], v[164:167]
    v_mfma_f32_16x16x32_bf16 v[168:171], v[232:235], v[46:49], v[168:171]
    v_mfma_f32_16x16x32_bf16 v[172:175], v[236:239], v[46:49], v[172:175]
k1_csB14:
    s_add_u32 m0, s54, 1024
    s_lshl_b32 s50, s100, 7
    s_add_u32 s50, s50, s53
    buffer_load_dwordx4 v9, s[4:7], s50 offen lds
    v_mfma_f32_32x32x16_bf16 v[64:79], v[188:191], v[240:243], v[64:79]
    ds_read_b128 v[180:183], v27
    ds_read_b64_tr_b16 v[208:209], v30 offset:1024
    v_lshlrev_b32 v50, 16, v188
    v_and_b32 v51, s48, v188
    v_add_f32 v6, v6, v50
    v_fmac_f32 v54, v50, v50
    v_add_f32 v7, v7, v51
    v_fmac_f32 v55, v51, v51
    v_mfma_f32_32x32x16_bf16 v[80:95], v[244:247], v[188:191], v[80:95]
    ds_read_b64_tr_b16 v[210:211], v30 offset:1280
    ds_read_b64_tr_b16 v[212:213], v30 offset:5120
    v_lshlrev_b32 v52, 16, v189
    v_and_b32 v53, s48, v189
    v_add_f32 v6, v6, v52
    v_fmac_f32 v54, v52, v52
    v_add_f32 v7, v7, v53
    v_fmac_f32 v55, v53, v53
    v_mfma_f32_32x32x16_bf16 v[96:111], v[248:251], v[188:191], v[96:111]
    ds_read_b64_tr_b16 v[214:215], v30 offset:5376
    ds_read_b64_tr_b16 v[216:217], v32 offset:2048
    v_lshlrev_b32 v50, 16, v190
    v_and_b32 v51, s48, v190
    v_add_f32 v6, v6, v50
    v_fmac_f32 v54, v50, v50
    v_add_f32 v7, v7, v51
    v_fmac_f32 v55, v51, v51
    v_mfma_f32_32x32x16_bf16 v[112:127], v[252:255], v[188:191], v[112:127]
    ds_read_b64_tr_b16 v[218:219], v32 offset:2560
    ds_read_b64_tr_b16 v[220:221], v33 offset:2048
    ds_read_b64_tr_b16 v[222:223], v33 offset:2560
    v_lshlrev_b32 v52, 16, v191
    v_and_b32 v53, s48, v191
    v_add_f32 v6, v6, v52
    v_fmac_f32 v54, v52, v52
    v_add_f32 v7, v7, v53
    v_fmac_f32 v55, v53, v53
    s_cmp_lg_u32 s43, 3
    s_cbranch_scc1 k1_csB15
    v_mfma_f32_16x16x32_bf16 v[160:163], v[240:243], v[46:49], v[160:163]
    v_mfma_f32_16x16x32_bf16 v[164:167], v[244:247], v[46:49], v[164:167]
    v_mfma_f32_16x16x32_bf16 v[168:171], v[248:251], v[46:49], v[168:171]
    v_mfma_f32_16x16x32_bf16 v[172:175], v[252:255], v[46:49], v[172:175]
k1_csB15:
    s_add_u32 m0, s57, 20480
    s_mul_i32 s50, s100, 196608
    s_add_u32 s50, s50, s55
    buffer_load_dwordx4 v10, s[8:11], s50 offen lds
    s_add_u32 m0, s57, 24576
    s_mul_i32 s50, s100, 196608
    s_add_u32 s50, s50, s56
    buffer_load_dwordx4 v10, s[8:11], s50 offen lds
    s_waitcnt lgkmcnt(15)
    v_mfma_f32_32x32x16_bf16 v[64:79], v[176:179], v[192:195], v[64:79]
    ds_read_b128 v[184:187], v28
    ds_read_b64_tr_b16 v[224:225], v30 offset:2048
    s_waitcnt lgkmcnt(15)
    v_mfma_f32_32x32x16_bf16 v[80:95], v[196:199], v[176:179], v[80:95]
    ds_read_b64_tr_b16 v[226:227], v30 offset:2304
    ds_read_b64_tr_b16 v[228:229], v30 offset:6144
    s_waitcnt lgkmcnt(15)
    v_mfma_f32_32x32x16_bf16 v[96:111], v[200:203], v[176:179], v[96:111]
    ds_read_b64_tr_b16 v[230:231], v30 offset:6400
    ds_read_b64_tr_b16 v[232:233], v32 offset:4096
    s_waitcnt lgkmcnt(15)
    v_mfma_f32_32x32x16_bf16 v[112:127], v[204:207], v[176:179], v[112:127]
    ds_read_b64_tr_b16 v[234:235], v32 offset:4608
    ds_read_b64_tr_b16 v[236:237], v33 offset:4096
    ds_read_b64_tr_b16 v[238:239], v33 offset:4608
    s_cmp_lg_u32 s43, 0
    s_cbranch_scc1 k1_csB16
    v_mfma_f32_16x16x32_bf16 v[160:163], v[192:195], v[46:49], v[160:163]
    v_mfma_f32_16x16x32_bf16 v[164:167], v[196:199], v[46:49], v[164:167]
    v_mfma_f32_16x16x32_bf16 v[168:171], v[200:203], v[46:49], v[168:171]
    v_mfma_f32_16x16x32_bf16 v[172:175], v[204:207], v[46:49], v[172:175]
k1_csB16:
    s_add_u32 m0, s51, 36864
    s_mul_i32 s50, s100, 229376
    s_add_u32 s50, s50, s58
    buffer_load_dwordx4 v11, s[20:23], s50 offen lds
    s_add_u32 m0, s51, 37888
    s_mul_i32 s50, s100, 229376
    s_add_u32 s50, s50, s58
    s_add_u32 s50, s50, 28672
    buffer_load_dwordx4 v11, s[20:23], s50 offen lds
    s_waitcnt lgkmcnt(15)
    v_mfma_f32_32x32x16_bf16 v[64:79], v[180:183], v[208:211], v[64:79]
    ds_read_b128 v[188:191], v29
    ds_read_b64_tr_b16 v[240:241], v30 offset:3072
    v_lshlrev_b32 v50, 16, v180
    v_and_b32 v51, s48, v180
    v_add_f32 v6, v6, v50
    v_fmac_f32 v54, v50, v50
    v_add_f32 v7, v7, v51
    v_fmac_f32 v55, v51, v51
    s_waitcnt lgkmcnt(15)
    v_mfma_f32_32x32x16_bf16 v[80:95], v[212:215], v[180:183], v[80:95]
    ds_read_b64_tr_b16 v[242:243], v30 offset:3328
    ds_read_b64_tr_b16 v[244:245], v30 offset:7168
    v_lshlrev_b32 v52, 16, v181
    v_and_b32 v53, s48, v181
    v_add_f32 v6, v6, v52
    v_fmac_f32 v54, v52, v52
    v_add_f32 v7, v7, v53
    v_fmac_f32 v55, v53, v53
    s_waitcnt lgkmcnt(15)
    v_mfma_f32_32x32x16_bf16 v[96:111], v[216:219], v[180:183], v[96:111]
    ds_read_b64_tr_b16 v[246:247], v30 offset:7424
    ds_read_b64_tr_b16 v[248:249], v32 offset:6144
    v_lshlrev_b32 v50, 16, v182
    v_and_b32 v51, s48, v182
    v_add_f32 v6, v6, v50
    v_fmac_f32 v54, v50, v50
    v_add_f32 v7, v7, v51
    v_fmac_f32 v55, v51, v51
    s_waitcnt lgkmcnt(15)
    v_mfma_f32_32x32x16_bf16 v[112:127], v[220:223], v[180:183], v[112:127]
    ds_read_b64_tr_b16 v[250:251], v32 offset:6656
    ds_read_b64_tr_b16 v[252:253], v33 offset:6144
    ds_read_b64_tr_b16 v[254:255], v33 offset:6656
    v_lshlrev_b32 v52, 16, v183
    v_and_b32 v53, s48, v183
    v_add_f32 v6, v6, v52
    v_fmac_f32 v54, v52, v52
    v_add_f32 v7, v7, v53
    v_fmac_f32 v55, v53, v53
    s_cmp_lg_u32 s43, 1
    s_cbranch_scc1 k1_csB17
    v_mfma_f32_16x16x32_bf16 v[160:163], v[208:211], v[46:49], v[160:163]
    v_mfma_f32_16x16x32_bf16 v[164:167], v[212:215], v[46:49], v[164:167]
    v_mfma_f32_16x16x32_bf16 v[168:171], v[216:219], v[46:49], v[168:171]
    v_mfma_f32_16x16x32_bf16 v[172:175], v[220:223], v[46:49], v[172:175]
k1_csB17:
    s_waitcnt vmcnt(6) lgkmcnt(0)
    s_barrier
    s_add_u32 s100, s101, 7
    s_and_b32 s100, s100, 7
    s_add_u32 m0, s54, 45056
    s_lshl_b32 s50, s100, 7
    s_add_u32 s50, s50, s52
    buffer_load_dwordx4 v8, s[4:7], s50 offen lds
    v_mfma_f32_32x32x16_bf16 v[64:79], v[184:187], v[224:227], v[64:79]
    ds_read_b128 v[176:179], v36
    ds_read_b64_tr_b16 v[192:193], v40 offset:0
    v_mfma_f32_32x32x16_bf16 v[80:95], v[228:231], v[184:187], v[80:95]
    ds_read_b64_tr_b16 v[194:195], v40 offset:256
    ds_read_b64_tr_b16 v[196:197], v40 offset:4096
    v_mfma_f32_32x32x16_bf16 v[96:111], v[232:235], v[184:187], v[96:111]
    ds_read_b64_tr_b16 v[198:199], v40 offset:4352
    ds_read_b64_tr_b16 v[200:201], v42 offset:0
    v_mfma_f32_32x32x16_bf16 v[112:127], v[236:239], v[184:187], v[112:127]
    ds_read_b64_tr_b16 v[202:203], v42 offset:512
    ds_read_b64_tr_b16 v[204:205], v43 offset:0
    ds_read_b64_tr_b16 v[206:207], v43 offset:512
    s_cmp_lg_u32 s43, 2
    s_cbranch_scc1 k1_csB18
    v_mfma_f32_16x16x32_bf16 v[160:163], v[224:227], v[46:49], v[160:163]
    v_mfma_f32_16x16x32_bf16 v[164:167], v[228:231], v[46:49], v[164:167]
    v_mfma_f32_16x16x32_bf16 v[168:171], v[232:235], v[46:49], v[168:171]
    v_mfma_f32_16x16x32_bf16 v[172:175], v[236:239], v[46:49], v[172:175]
k1_csB18:
    s_add_u32 m0, s54, 46080
    s_lshl_b32 s50, s100, 7
    s_add_u32 s50, s50, s53
    buffer_load_dwordx4 v9, s[4:7], s50 offen lds
    v_mfma_f32_32x32x16_bf16 v[64:79], v[188:191], v[240:243], v[64:79]
    ds_read_b128 v[180:183], v37
    ds_read_b64_tr_b16 v[208:209], v40 offset:1024
    v_lshlrev_b32 v50, 16, v188
    v_and_b32 v51, s48, v188
    v_add_f32 v6, v6, v50
    v_fmac_f32 v54, v50, v50
    v_add_f32 v7, v7, v51
    v_fmac_f32 v55, v51, v51
    v_mfma_f32_32x32x16_bf16 v[80:95], v[244:247], v[188:191], v[80:95]
    ds_read_b64_tr_b16 v[210:211], v40 offset:1280
    ds_read_b64_tr_b16 v[212:213], v40 offset:5120
    v_lshlrev_b32 v52, 16, v189
    v_and_b32 v53, s48, v189
    v_add_f32 v6, v6, v52
    v_fmac_f32 v54, v52, v52
    v_add_f32 v7, v7, v53
    v_fmac_f32 v55, v53, v53
    v_mfma_f32_32x32x16_bf16 v[96:111], v[248:251], v[188:191], v[96:111]
    ds_read_b64_tr_b16 v[214:215], v40 offset:5376
    ds_read_b64_tr_b16 v[216:217], v42 offset:2048
    v_lshlrev_b32 v50, 16, v190
    v_and_b32 v51, s48, v190
    v_add_f32 v6, v6, v50
    v_fmac_f32 v54, v50, v50
    v_add_f32 v7, v7, v51
    v_fmac_f32 v55, v51, v51
    v_mfma_f32_32x32x16_bf16 v[112:127], v[252:255], v[188:191], v[112:127]
    ds_read_b64_tr_b16 v[218:219], v42 offset:2560
    ds_read_b64_tr_b16 v[220:221], v43 offset:2048
    ds_read_b64_tr_b16 v[222:223], v43 offset:2560
    v_lshlrev_b32 v52, 16, v191
    v_and_b32 v53, s48, v191
    v_add_f32 v6, v6, v52
    v_fmac_f32 v54, v52, v52
    v_add_f32 v7, v7, v53
    v_fmac_f32 v55, v53, v53
    s_cmp_lg_u32 s43, 3
    s_cbranch_scc1 k1_csB19
    v_mfma_f32_16x16x32_bf16 v[160:163], v[240:243], v[46:49], v[160:163]
    v_mfma_f32_16x16x32_bf16 v[164:167], v[244:247], v[46:49], v[164:167]
    v_mfma_f32_16x16x32_bf16 v[168:171], v[248:251], v[46:49], v[168:171]
    v_mfma_f32_16x16x32_bf16 v[172:175], v[252:255], v[46:49], v[172:175]
k1_csB19:
    s_add_u32 m0, s57, 65536
    s_mul_i32 s50, s100, 196608
    s_add_u32 s50, s50, s55
    buffer_load_dwordx4 v10, s[8:11], s50 offen lds
    s_add_u32 m0, s57, 69632
    s_mul_i32 s50, s100, 196608
    s_add_u32 s50, s50, s56
    buffer_load_dwordx4 v10, s[8:11], s50 offen lds
    s_waitcnt lgkmcnt(15)
    v_mfma_f32_32x32x16_bf16 v[64:79], v[176:179], v[192:195], v[64:79]
    ds_read_b128 v[184:187], v38
    ds_read_b64_tr_b16 v[224:225], v40 offset:2048
    s_waitcnt lgkmcnt(15)
    v_mfma_f32_32x32x16_bf16 v[80:95], v[196:199], v[176:179], v[80:95]
    ds_read_b64_tr_b16 v[226:227], v40 offset:2304
    ds_read_b64_tr_b16 v[228:229], v40 offset:6144
    s_waitcnt lgkmcnt(15)
    v_mfma_f32_32x32x16_bf16 v[96:111], v[200:203], v[176:179], v[96:111]
    ds_read_b64_tr_b16 v[230:231], v40 offset:6400
    ds_read_b64_tr_b16 v[232:233], v42 offset:4096
    s_waitcnt lgkmcnt(15)
    v_mfma_f32_32x32x16_bf16 v[112:127], v[204:207], v[176:179], v[112:127]
    ds_read_b64_tr_b16 v[234:235], v42 offset:4608
    ds_read_b64_tr_b16 v[236:237], v43 offset:4096
    ds_read_b64_tr_b16 v[238:239], v43 offset:4608
    s_cmp_lg_u32 s43, 0
    s_cbranch_scc1 k1_csB20
    v_mfma_f32_16x16x32_bf16 v[160:163], v[192:195], v[46:49], v[160:163]
    v_mfma_f32_16x16x32_bf16 v[164:167], v[196:199], v[46:49], v[164:167]
    v_mfma_f32_16x16x32_bf16 v[168:171], v[200:203], v[46:49], v[168:171]
    v_mfma_f32_16x16x32_bf16 v[172:175], v[204:207], v[46:49], v[172:175]
k1_csB20:
    s_add_u32 m0, s51, 81920
    s_mul_i32 s50, s100, 229376
    s_add_u32 s50, s50, s58
    buffer_load_dwordx4 v11, s[20:23], s50 offen lds
    s_add_u32 m0, s51, 82944
    s_mul_i32 s50, s100, 229376
    s_add_u32 s50, s50, s58
    s_add_u32 s50, s50, 28672
    buffer_load_dwordx4 v11, s[20:23], s50 offen lds
    s_waitcnt lgkmcnt(15)
    v_mfma_f32_32x32x16_bf16 v[64:79], v[180:183], v[208:211], v[64:79]
    ds_read_b128 v[188:191], v39
    ds_read_b64_tr_b16 v[240:241], v40 offset:3072
    v_lshlrev_b32 v50, 16, v180
    v_and_b32 v51, s48, v180
    v_add_f32 v6, v6, v50
    v_fmac_f32 v54, v50, v50
    v_add_f32 v7, v7, v51
    v_fmac_f32 v55, v51, v51
    s_waitcnt lgkmcnt(15)
    v_mfma_f32_32x32x16_bf16 v[80:95], v[212:215], v[180:183], v[80:95]
    ds_read_b64_tr_b16 v[242:243], v40 offset:3328
    ds_read_b64_tr_b16 v[244:245], v40 offset:7168
    v_lshlrev_b32 v52, 16, v181
    v_and_b32 v53, s48, v181
    v_add_f32 v6, v6, v52
    v_fmac_f32 v54, v52, v52
    v_add_f32 v7, v7, v53
    v_fmac_f32 v55, v53, v53
    s_waitcnt lgkmcnt(15)
    v_mfma_f32_32x32x16_bf16 v[96:111], v[216:219], v[180:183], v[96:111]
    ds_read_b64_tr_b16 v[246:247], v40 offset:7424
    ds_read_b64_tr_b16 v[248:249], v42 offset:6144
    v_lshlrev_b32 v50, 16, v182
    v_and_b32 v51, s48, v182
    v_add_f32 v6, v6, v50
    v_fmac_f32 v54, v50, v50
    v_add_f32 v7, v7, v51
    v_fmac_f32 v55, v51, v51
    s_waitcnt lgkmcnt(15)
    v_mfma_f32_32x32x16_bf16 v[112:127], v[220:223], v[180:183], v[112:127]
    ds_read_b64_tr_b16 v[250:251], v42 offset:6656
    ds_read_b64_tr_b16 v[252:253], v43 offset:6144
    ds_read_b64_tr_b16 v[254:255], v43 offset:6656
    v_lshlrev_b32 v52, 16, v183
    v_and_b32 v53, s48, v183
    v_add_f32 v6, v6, v52
    v_fmac_f32 v54, v52, v52
    v_add_f32 v7, v7, v53
    v_fmac_f32 v55, v53, v53
    s_cmp_lg_u32 s43, 1
    s_cbranch_scc1 k1_csB21
    v_mfma_f32_16x16x32_bf16 v[160:163], v[208:211], v[46:49], v[160:163]
    v_mfma_f32_16x16x32_bf16 v[164:167], v[212:215], v[46:49], v[164:167]
    v_mfma_f32_16x16x32_bf16 v[168:171], v[216:219], v[46:49], v[168:171]
    v_mfma_f32_16x16x32_bf16 v[172:175], v[220:223], v[46:49], v[172:175]
k1_csB21:
    s_waitcnt vmcnt(6) lgkmcnt(0)
    s_barrier
    v_mfma_f32_32x32x16_bf16 v[64:79], v[184:187], v[224:227], v[64:79]
    ds_read_b128 v[176:179], v16
    ds_read_b64_tr_b16 v[192:193], v20 offset:0
    v_mfma_f32_32x32x16_bf16 v[80:95], v[228:231], v[184:187], v[80:95]
    ds_read_b64_tr_b16 v[194:195], v20 offset:256
    ds_read_b64_tr_b16 v[196:197], v20 offset:4096
    v_mfma_f32_32x32x16_bf16 v[96:111], v[232:235], v[184:187], v[96:111]
    ds_read_b64_tr_b16 v[198:199], v20 offset:4352
    ds_read_b64_tr_b16 v[200:201], v22 offset:0
    v_mfma_f32_32x32x16_bf16 v[112:127], v[236:239], v[184:187], v[112:127]
    ds_read_b64_tr_b16 v[202:203], v22 offset:512
    ds_read_b64_tr_b16 v[204:205], v23 offset:0
    ds_read_b64_tr_b16 v[206:207], v23 offset:512
    s_cmp_lg_u32 s43, 2
    s_cbranch_scc1 k1_csB22
    v_mfma_f32_16x16x32_bf16 v[160:163], v[224:227], v[46:49], v[160:163]
    v_mfma_f32_16x16x32_bf16 v[164:167], v[228:231], v[46:49], v[164:167]
    v_mfma_f32_16x16x32_bf16 v[168:171], v[232:235], v[46:49], v[168:171]
    v_mfma_f32_16x16x32_bf16 v[172:175], v[236:239], v[46:49], v[172:175]
k1_csB22:
    v_mfma_f32_32x32x16_bf16 v[64:79], v[188:191], v[240:243], v[64:79]
    ds_read_b128 v[180:183], v17
    ds_read_b64_tr_b16 v[208:209], v20 offset:1024
    v_lshlrev_b32 v50, 16, v188
    v_and_b32 v51, s48, v188
    v_add_f32 v6, v6, v50
    v_fmac_f32 v54, v50, v50
    v_add_f32 v7, v7, v51
    v_fmac_f32 v55, v51, v51
    v_mfma_f32_32x32x16_bf16 v[80:95], v[244:247], v[188:191], v[80:95]
    ds_read_b64_tr_b16 v[210:211], v20 offset:1280
    ds_read_b64_tr_b16 v[212:213], v20 offset:5120
    v_lshlrev_b32 v52, 16, v189
    v_and_b32 v53, s48, v189
    v_add_f32 v6, v6, v52
    v_fmac_f32 v54, v52, v52
    v_add_f32 v7, v7, v53
    v_fmac_f32 v55, v53, v53
    v_mfma_f32_32x32x16_bf16 v[96:111], v[248:251], v[188:191], v[96:111]
    ds_read_b64_tr_b16 v[214:215], v20 offset:5376
    ds_read_b64_tr_b16 v[216:217], v22 offset:2048
    v_lshlrev_b32 v50, 16, v190
    v_and_b32 v51, s48, v190
    v_add_f32 v6, v6, v50
    v_fmac_f32 v54, v50, v50
    v_add_f32 v7, v7, v51
    v_fmac_f32 v55, v51, v51
    v_mfma_f32_32x32x16_bf16 v[112:127], v[252:255], v[188:191], v[112:127]
    ds_read_b64_tr_b16 v[218:219], v22 offset:2560
    ds_read_b64_tr_b16 v[220:221], v23 offset:2048
    ds_read_b64_tr_b16 v[222:223], v23 offset:2560
    v_lshlrev_b32 v52, 16, v191
    v_and_b32 v53, s48, v191
    v_add_f32 v6, v6, v52
    v_fmac_f32 v54, v52, v52
    v_add_f32 v7, v7, v53
    v_fmac_f32 v55, v53, v53
    s_cmp_lg_u32 s43, 3
    s_cbranch_scc1 k1_csB23
    v_mfma_f32_16x16x32_bf16 v[160:163], v[240:243], v[46:49], v[160:163]
    v_mfma_f32_16x16x32_bf16 v[164:167], v[244:247], v[46:49], v[164:167]
    v_mfma_f32_16x16x32_bf16 v[168:171], v[248:251], v[46:49], v[168:171]
    v_mfma_f32_16x16x32_bf16 v[172:175], v[252:255], v[46:49], v[172:175]
k1_csB23:
    s_waitcnt lgkmcnt(15)
    v_mfma_f32_32x32x16_bf16 v[64:79], v[176:179], v[192:195], v[64:79]
    ds_read_b128 v[184:187], v18
    ds_read_b64_tr_b16 v[224:225], v20 offset:2048
    s_waitcnt lgkmcnt(15)
    v_mfma_f32_32x32x16_bf16 v[80:95], v[196:199], v[176:179], v[80:95]
    ds_read_b64_tr_b16 v[226:227], v20 offset:2304
    ds_read_b64_tr_b16 v[228:229], v20 offset:6144
    s_waitcnt lgkmcnt(15)
    v_mfma_f32_32x32x16_bf16 v[96:111], v[200:203], v[176:179], v[96:111]
    ds_read_b64_tr_b16 v[230:231], v20 offset:6400
    ds_read_b64_tr_b16 v[232:233], v22 offset:4096
    s_waitcnt lgkmcnt(15)
    v_mfma_f32_32x32x16_bf16 v[112:127], v[204:207], v[176:179], v[112:127]
    ds_read_b64_tr_b16 v[234:235], v22 offset:4608
    ds_read_b64_tr_b16 v[236:237], v23 offset:4096
    ds_read_b64_tr_b16 v[238:239], v23 offset:4608
    s_cmp_lg_u32 s43, 0
    s_cbranch_scc1 k1_csB24
    v_mfma_f32_16x16x32_bf16 v[160:163], v[192:195], v[46:49], v[160:163]
    v_mfma_f32_16x16x32_bf16 v[164:167], v[196:199], v[46:49], v[164:167]
    v_mfma_f32_16x16x32_bf16 v[168:171], v[200:203], v[46:49], v[168:171]
    v_mfma_f32_16x16x32_bf16 v[172:175], v[204:207], v[46:49], v[172:175]
k1_csB24:
    s_waitcnt lgkmcnt(15)
    v_mfma_f32_32x32x16_bf16 v[64:79], v[180:183], v[208:211], v[64:79]
    ds_read_b128 v[188:191], v19
    ds_read_b64_tr_b16 v[240:241], v20 offset:3072
    v_lshlrev_b32 v50, 16, v180
    v_and_b32 v51, s48, v180
    v_add_f32 v6, v6, v50
    v_fmac_f32 v54, v50, v50
    v_add_f32 v7, v7, v51
    v_fmac_f32 v55, v51, v51
    s_waitcnt lgkmcnt(15)
    v_mfma_f32_32x32x16_bf16 v[80:95], v[212:215], v[180:183], v[80:95]
    ds_read_b64_tr_b16 v[242:243], v20 offset:3328
    ds_read_b64_tr_b16 v[244:245], v20 offset:7168
    v_lshlrev_b32 v52, 16, v181
    v_and_b32 v53, s48, v181
    v_add_f32 v6, v6, v52
    v_fmac_f32 v54, v52, v52
    v_add_f32 v7, v7, v53
    v_fmac_f32 v55, v53, v53
    s_waitcnt lgkmcnt(15)
    v_mfma_f32_32x32x16_bf16 v[96:111], v[216:219], v[180:183], v[96:111]
    ds_read_b64_tr_b16 v[246:247], v20 offset:7424
    ds_read_b64_tr_b16 v[248:249], v22 offset:6144
    v_lshlrev_b32 v50, 16, v182
    v_and_b32 v51, s48, v182
    v_add_f32 v6, v6, v50
    v_fmac_f32 v54, v50, v50
    v_add_f32 v7, v7, v51
    v_fmac_f32 v55, v51, v51
    s_waitcnt lgkmcnt(15)
    v_mfma_f32_32x32x16_bf16 v[112:127], v[220:223], v[180:183], v[112:127]
    ds_read_b64_tr_b16 v[250:251], v22 offset:6656
    ds_read_b64_tr_b16 v[252:253], v23 offset:6144
    ds_read_b64_tr_b16 v[254:255], v23 offset:6656
    v_lshlrev_b32 v52, 16, v183
    v_and_b32 v53, s48, v183
    v_add_f32 v6, v6, v52
    v_fmac_f32 v54, v52, v52
    v_add_f32 v7, v7, v53
    v_fmac_f32 v55, v53, v53
    s_cmp_lg_u32 s43, 1
    s_cbranch_scc1 k1_csB25
    v_mfma_f32_16x16x32_bf16 v[160:163], v[208:211], v[46:49], v[160:163]
    v_mfma_f32_16x16x32_bf16 v[164:167], v[212:215], v[46:49], v[164:167]
    v_mfma_f32_16x16x32_bf16 v[168:171], v[216:219], v[46:49], v[168:171]
    v_mfma_f32_16x16x32_bf16 v[172:175], v[220:223], v[46:49], v[172:175]
k1_csB25:
    s_waitcnt vmcnt(0) lgkmcnt(0)
    s_barrier
    v_mfma_f32_32x32x16_bf16 v[64:79], v[184:187], v[224:227], v[64:79]
    ds_read_b128 v[176:179], v26
    ds_read_b64_tr_b16 v[192:193], v30 offset:0
    v_mfma_f32_32x32x16_bf16 v[80:95], v[228:231], v[184:187], v[80:95]
    ds_read_b64_tr_b16 v[194:195], v30 offset:256
    ds_read_b64_tr_b16 v[196:197], v30 offset:4096
    v_mfma_f32_32x32x16_bf16 v[96:111], v[232:235], v[184:187], v[96:111]
    ds_read_b64_tr_b16 v[198:199], v30 offset:4352
    ds_read_b64_tr_b16 v[200:201], v32 offset:0
    v_mfma_f32_32x32x16_bf16 v[112:127], v[236:239], v[184:187], v[112:127]
    ds_read_b64_tr_b16 v[202:203], v32 offset:512
    ds_read_b64_tr_b16 v[204:205], v33 offset:0
    ds_read_b64_tr_b16 v[206:207], v33 offset:512
    s_cmp_lg_u32 s43, 2
    s_cbranch_scc1 k1_csB26
    v_mfma_f32_16x16x32_bf16 v[160:163], v[224:227], v[46:49], v[160:163]
    v_mfma_f32_16x16x32_bf16 v[164:167], v[228:231], v[46:49], v[164:167]
    v_mfma_f32_16x16x32_bf16 v[168:171], v[232:235], v[46:49], v[168:171]
    v_mfma_f32_16x16x32_bf16 v[172:175], v[236:239], v[46:49], v[172:175]
k1_csB26:
    v_mfma_f32_32x32x16_bf16 v[64:79], v[188:191], v[240:243], v[64:79]
    ds_read_b128 v[180:183], v27
    ds_read_b64_tr_b16 v[208:209], v30 offset:1024
    v_lshlrev_b32 v50, 16, v188
    v_and_b32 v51, s48, v188
    v_add_f32 v6, v6, v50
    v_fmac_f32 v54, v50, v50
    v_add_f32 v7, v7, v51
    v_fmac_f32 v55, v51, v51
    v_mfma_f32_32x32x16_bf16 v[80:95], v[244:247], v[188:191], v[80:95]
    ds_read_b64_tr_b16 v[210:211], v30 offset:1280
    ds_read_b64_tr_b16 v[212:213], v30 offset:5120
    v_lshlrev_b32 v52, 16, v189
    v_and_b32 v53, s48, v189
    v_add_f32 v6, v6, v52
    v_fmac_f32 v54, v52, v52
    v_add_f32 v7, v7, v53
    v_fmac_f32 v55, v53, v53
    v_mfma_f32_32x32x16_bf16 v[96:111], v[248:251], v[188:191], v[96:111]
    ds_read_b64_tr_b16 v[214:215], v30 offset:5376
    ds_read_b64_tr_b16 v[216:217], v32 offset:2048
    v_lshlrev_b32 v50, 16, v190
    v_and_b32 v51, s48, v190
    v_add_f32 v6, v6, v50
    v_fmac_f32 v54, v50, v50
    v_add_f32 v7, v7, v51
    v_fmac_f32 v55, v51, v51
    v_mfma_f32_32x32x16_bf16 v[112:127], v[252:255], v[188:191], v[112:127]
    ds_read_b64_tr_b16 v[218:219], v32 offset:2560
    ds_read_b64_tr_b16 v[220:221], v33 offset:2048
    ds_read_b64_tr_b16 v[222:223], v33 offset:2560
    v_lshlrev_b32 v52, 16, v191
    v_and_b32 v53, s48, v191
    v_add_f32 v6, v6, v52
    v_fmac_f32 v54, v52, v52
    v_add_f32 v7, v7, v53
    v_fmac_f32 v55, v53, v53
    s_cmp_lg_u32 s43, 3
    s_cbranch_scc1 k1_csB27
    v_mfma_f32_16x16x32_bf16 v[160:163], v[240:243], v[46:49], v[160:163]
    v_mfma_f32_16x16x32_bf16 v[164:167], v[244:247], v[46:49], v[164:167]
    v_mfma_f32_16x16x32_bf16 v[168:171], v[248:251], v[46:49], v[168:171]
    v_mfma_f32_16x16x32_bf16 v[172:175], v[252:255], v[46:49], v[172:175]
k1_csB27:
    s_waitcnt lgkmcnt(15)
    v_mfma_f32_32x32x16_bf16 v[64:79], v[176:179], v[192:195], v[64:79]
    ds_read_b128 v[184:187], v28
    ds_read_b64_tr_b16 v[224:225], v30 offset:2048
    s_waitcnt lgkmcnt(15)
    v_mfma_f32_32x32x16_bf16 v[80:95], v[196:199], v[176:179], v[80:95]
    ds_read_b64_tr_b16 v[226:227], v30 offset:2304
    ds_read_b64_tr_b16 v[228:229], v30 offset:6144
    s_waitcnt lgkmcnt(15)
    v_mfma_f32_32x32x16_bf16 v[96:111], v[200:203], v[176:179], v[96:111]
    ds_read_b64_tr_b16 v[230:231], v30 offset:6400
    ds_read_b64_tr_b16 v[232:233], v32 offset:4096
    s_waitcnt lgkmcnt(15)
    v_mfma_f32_32x32x16_bf16 v[112:127], v[204:207], v[176:179], v[112:127]
    ds_read_b64_tr_b16 v[234:235], v32 offset:4608
    ds_read_b64_tr_b16 v[236:237], v33 offset:4096
    ds_read_b64_tr_b16 v[238:239], v33 offset:4608
    s_cmp_lg_u32 s43, 0
    s_cbranch_scc1 k1_csB28
    v_mfma_f32_16x16x32_bf16 v[160:163], v[192:195], v[46:49], v[160:163]
    v_mfma_f32_16x16x32_bf16 v[164:167], v[196:199], v[46:49], v[164:167]
    v_mfma_f32_16x16x32_bf16 v[168:171], v[200:203], v[46:49], v[168:171]
    v_mfma_f32_16x16x32_bf16 v[172:175], v[204:207], v[46:49], v[172:175]
k1_csB28:
    s_waitcnt lgkmcnt(15)
    v_mfma_f32_32x32x16_bf16 v[64:79], v[180:183], v[208:211], v[64:79]
    ds_read_b128 v[188:191], v29
    ds_read_b64_tr_b16 v[240:241], v30 offset:3072
    v_lshlrev_b32 v50, 16, v180
    v_and_b32 v51, s48, v180
    v_add_f32 v6, v6, v50
    v_fmac_f32 v54, v50, v50
    v_add_f32 v7, v7, v51
    v_fmac_f32 v55, v51, v51
    s_waitcnt lgkmcnt(15)
    v_mfma_f32_32x32x16_bf16 v[80:95], v[212:215], v[180:183], v[80:95]
    ds_read_b64_tr_b16 v[242:243], v30 offset:3328
    ds_read_b64_tr_b16 v[244:245], v30 offset:7168
    v_lshlrev_b32 v52, 16, v181
    v_and_b32 v53, s48, v181
    v_add_f32 v6, v6, v52
    v_fmac_f32 v54, v52, v52
    v_add_f32 v7, v7, v53
    v_fmac_f32 v55, v53, v53
    s_waitcnt lgkmcnt(15)
    v_mfma_f32_32x32x16_bf16 v[96:111], v[216:219], v[180:183], v[96:111]
    ds_read_b64_tr_b16 v[246:247], v30 offset:7424
    ds_read_b64_tr_b16 v[248:249], v32 offset:6144
    v_lshlrev_b32 v50, 16, v182
    v_and_b32 v51, s48, v182
    v_add_f32 v6, v6, v50
    v_fmac_f32 v54, v50, v50
    v_add_f32 v7, v7, v51
    v_fmac_f32 v55, v51, v51
    s_waitcnt lgkmcnt(15)
    v_mfma_f32_32x32x16_bf16 v[112:127], v[220:223], v[180:183], v[112:127]
    ds_read_b64_tr_b16 v[250:251], v32 offset:6656
    ds_read_b64_tr_b16 v[252:253], v33 offset:6144
    ds_read_b64_tr_b16 v[254:255], v33 offset:6656
    v_lshlrev_b32 v52, 16, v183
    v_and_b32 v53, s48, v183
    v_add_f32 v6, v6, v52
    v_fmac_f32 v54, v52, v52
    v_add_f32 v7, v7, v53
    v_fmac_f32 v55, v53, v53
    s_cmp_lg_u32 s43, 1
    s_cbranch_scc1 k1_csB29
    v_mfma_f32_16x16x32_bf16 v[160:163], v[208:211], v[46:49], v[160:163]
    v_mfma_f32_16x16x32_bf16 v[164:167], v[212:215], v[46:49], v[164:167]
    v_mfma_f32_16x16x32_bf16 v[168:171], v[216:219], v[46:49], v[168:171]
    v_mfma_f32_16x16x32_bf16 v[172:175], v[220:223], v[46:49], v[172:175]
k1_csB29:
    s_waitcnt lgkmcnt(15)
    v_mfma_f32_32x32x16_bf16 v[64:79], v[184:187], v[224:227], v[64:79]
    s_waitcnt lgkmcnt(13)
    v_mfma_f32_32x32x16_bf16 v[80:95], v[228:231], v[184:187], v[80:95]
    s_waitcnt lgkmcnt(11)
    v_mfma_f32_32x32x16_bf16 v[96:111], v[232:235], v[184:187], v[96:111]
    s_waitcnt lgkmcnt(9)
    v_mfma_f32_32x32x16_bf16 v[112:127], v[236:239], v[184:187], v[112:127]
    s_cmp_lg_u32 s43, 2
    s_cbranch_scc1 k1_csB30
    v_mfma_f32_16x16x32_bf16 v[160:163], v[224:227], v[46:49], v[160:163]
    v_mfma_f32_16x16x32_bf16 v[164:167], v[228:231], v[46:49], v[164:167]
    v_mfma_f32_16x16x32_bf16 v[168:171], v[232:235], v[46:49], v[168:171]
    v_mfma_f32_16x16x32_bf16 v[172:175], v[236:239], v[46:49], v[172:175]
k1_csB30:
    s_waitcnt lgkmcnt(6)
    v_mfma_f32_32x32x16_bf16 v[64:79], v[188:191], v[240:243], v[64:79]
    v_lshlrev_b32 v50, 16, v188
    v_and_b32 v51, s48, v188
    v_add_f32 v6, v6, v50
    v_fmac_f32 v54, v50, v50
    v_add_f32 v7, v7, v51
    v_fmac_f32 v55, v51, v51
    s_waitcnt lgkmcnt(4)
    v_mfma_f32_32x32x16_bf16 v[80:95], v[244:247], v[188:191], v[80:95]
    v_lshlrev_b32 v52, 16, v189
    v_and_b32 v53, s48, v189
    v_add_f32 v6, v6, v52
    v_fmac_f32 v54, v52, v52
    v_add_f32 v7, v7, v53
    v_fmac_f32 v55, v53, v53
    s_waitcnt lgkmcnt(2)
    v_mfma_f32_32x32x16_bf16 v[96:111], v[248:251], v[188:191], v[96:111]
    v_lshlrev_b32 v50, 16, v190
    v_and_b32 v51, s48, v190
    v_add_f32 v6, v6, v50
    v_fmac_f32 v54, v50, v50
    v_add_f32 v7, v7, v51
    v_fmac_f32 v55, v51, v51
    s_waitcnt lgkmcnt(0)
    v_mfma_f32_32x32x16_bf16 v[112:127], v[252:255], v[188:191], v[112:127]
    v_lshlrev_b32 v52, 16, v191
    v_and_b32 v53, s48, v191
    v_add_f32 v6, v6, v52
    v_fmac_f32 v54, v52, v52
    v_add_f32 v7, v7, v53
    v_fmac_f32 v55, v53, v53
    s_cmp_lg_u32 s43, 3
    s_cbranch_scc1 k1_csB31
    v_mfma_f32_16x16x32_bf16 v[160:163], v[240:243], v[46:49], v[160:163]
    v_mfma_f32_16x16x32_bf16 v[164:167], v[244:247], v[46:49], v[164:167]
    v_mfma_f32_16x16x32_bf16 v[168:171], v[248:251], v[46:49], v[168:171]
    v_mfma_f32_16x16x32_bf16 v[172:175], v[252:255], v[46:49], v[172:175]
k1_csB31:
    v_add_f32 v6, v6, v7
    v_add_f32 v7, v54, v55
    s_lshl_b32 s60, s43, 9
    s_add_u32 s60, s60, 145408
    v_lshlrev_b32 v12, 4, v2
    v_lshlrev_b32 v13, 3, v3
    v_add_u32 v12, v12, v13
    v_add_u32 v12, s60, v12
    ds_write_b64 v12, v[6:7]
    v_and_b32 v14, 15, v1
    v_lshlrev_b32 v12, 6, v14
    v_lshrrev_b32 v15, 4, v1
    v_lshlrev_b32 v15, 4, v15
    v_add_u32 v12, v12, v15
    v_add_u32 v12, 147968, v12
    v_cmp_gt_u32 vcc, 2, v14
    s_lshl_b32 s60, s43, 7
    v_add_u32 v12, s60, v12
    s_and_saveexec_b64 s[62:63], vcc
    ds_write_b128 v12, v[160:163] offset:0
    ds_write_b128 v12, v[164:167] offset:512
    s_mov_b64 exec, s[62:63]
    v_and_b32 v14, 15, v1
    v_lshlrev_b32 v12, 6, v14
    v_lshrrev_b32 v15, 4, v1
    v_lshlrev_b32 v15, 4, v15
    v_add_u32 v12, v12, v15
    v_add_u32 v12, 150528, v12
    v_cmp_gt_u32 vcc, 2, v14
    s_lshl_b32 s60, s43, 7
    v_add_u32 v12, s60, v12
    s_and_saveexec_b64 s[62:63], vcc
    ds_write_b128 v12, v[168:171] offset:0
    ds_write_b128 v12, v[172:175] offset:512
    s_mov_b64 exec, s[62:63]
    s_waitcnt lgkmcnt(0)
    s_barrier
    s_lshl_b32 s60, s42, 4
    v_mov_b32 v148, s60
    buffer_load_dword v149, v148, s[32:35], 0 offen sc1
    s_lshl_b32 s60, s40, 9
    s_add_u32 s60, s60, 147456
    v_lshlrev_b32 v12, 2, v2
    v_add_u32 v13, s60, v12
    ds_read_b32 v8, v13 offset:0
    ds_read_b32 v9, v13 offset:128
    ds_read_b32 v10, v13 offset:256
    ds_read_b32 v11, v13 offset:384
    s_lshl_b32 s60, s40, 7
    s_add_u32 s60, s60, 137216
    v_add_u32 v12, s60, v12
    s_waitcnt lgkmcnt(2)
    v_add_f32 v8, v8, v9
    s_waitcnt lgkmcnt(0)
    v_add_f32 v10, v10, v11
    v_add_f32 v8, v8, v10
    ds_write_b32 v12, v8
    s_lshl_b32 s60, s43, 9
    v_lshlrev_b32 v16, 4, v2
    v_add_u32 v16, s60, v16
    v_add_u32 v16, 143360, v16
    ds_read_b128 v[20:23], v16
    ds_read_b128 v[24:27], v16 offset:2048
    s_waitcnt lgkmcnt(1)
    v_add_f32 v18, v20, v22
    s_waitcnt lgkmcnt(0)
    v_add_f32 v19, v24, v26
    v_add_f32 v18, v18, v19
    v_add_f32 v20, v21, v23
    v_add_f32 v19, v25, v27
    v_add_f32 v20, v20, v19
    v_mul_f32 v18, 0x3b000000, v18
    v_mul_f32 v20, 0x3b000000, v20
    v_fma_f32 v20, -v18, v18, v20
    v_max_f32 v20, 0, v20
    v_cvt_pk_bf16_f32 v22, v18, v18
    v_lshlrev_b32 v18, 16, v22
    v_cvt_pk_bf16_f32 v23, v20, v20
    v_lshlrev_b32 v20, 16, v23
    v_add_f32 v20, 0x3727c5ac, v20
    v_cvt_pk_bf16_f32 v23, v20, v20
    v_lshlrev_b32 v20, 16, v23
    v_sqrt_f32 v20, v20
    s_nop 0
    v_cvt_pk_bf16_f32 v23, v20, v20
    v_lshlrev_b32 v20, 16, v23
    v_rcp_f32 v6, v20
    s_nop 0
    v_mul_f32 v7, v18, v6
    s_waitcnt lgkmcnt(0)
    s_barrier
    s_lshl_b32 s60, s43, 8
    s_add_u32 s60, s60, 139264
    v_lshlrev_b32 v16, 2, v2
    v_add_u32 v16, s60, v16
    ds_write_b32 v16, v6
    ds_write_b32 v16, v7 offset:128
    v_lshlrev_b32 v14, 4, v3
    v_add_u32 v14, s60, v14
    ds_read_b128 v[16:19], v14 offset:128
    ds_read_b128 v[20:23], v14 offset:160
    ds_read_b128 v[24:27], v14 offset:192
    ds_read_b128 v[28:31], v14 offset:224
    v_lshlrev_b32 v15, 2, v2
    v_add_u32 v15, 137344, v15
    ds_read_b32 v10, v15
    ds_read_b128 v[32:35], v14 offset:0
    ds_read_b128 v[36:39], v14 offset:32
    ds_read_b128 v[40:43], v14 offset:64
    ds_read_b128 v[44:47], v14 offset:96
    s_waitcnt lgkmcnt(4)
    v_mul_f32 v16, v16, v10
    s_waitcnt lgkmcnt(3)
    v_fma_f32 v64, v64, v32, -v16
    v_mul_f32 v17, v17, v10
    v_fma_f32 v65, v65, v33, -v17
    v_mul_f32 v18, v18, v10
    v_fma_f32 v66, v66, v34, -v18
    v_mul_f32 v19, v19, v10
    v_fma_f32 v67, v67, v35, -v19
    v_mul_f32 v20, v20, v10
    s_waitcnt lgkmcnt(2)
    v_fma_f32 v68, v68, v36, -v20
    v_mul_f32 v21, v21, v10
    v_fma_f32 v69, v69, v37, -v21
    v_mul_f32 v22, v22, v10
    v_fma_f32 v70, v70, v38, -v22
    v_mul_f32 v23, v23, v10
    v_fma_f32 v71, v71, v39, -v23
    v_mul_f32 v24, v24, v10
    s_waitcnt lgkmcnt(1)
    v_fma_f32 v72, v72, v40, -v24
    v_mul_f32 v25, v25, v10
    v_fma_f32 v73, v73, v41, -v25
    v_mul_f32 v26, v26, v10
    v_fma_f32 v74, v74, v42, -v26
    v_mul_f32 v27, v27, v10
    v_fma_f32 v75, v75, v43, -v27
    v_mul_f32 v28, v28, v10
    s_waitcnt lgkmcnt(0)
    v_fma_f32 v76, v76, v44, -v28
    v_mul_f32 v29, v29, v10
    v_fma_f32 v77, v77, v45, -v29
    v_mul_f32 v30, v30, v10
    v_fma_f32 v78, v78, v46, -v30
    v_mul_f32 v31, v31, v10
    v_fma_f32 v79, v79, v47, -v31
    v_cvt_pk_bf16_f32 v48, v64, v65
    v_cvt_pk_bf16_f32 v49, v66, v67
    v_cvt_pk_bf16_f32 v50, v68, v69
    v_cvt_pk_bf16_f32 v51, v70, v71
    v_cvt_pk_bf16_f32 v52, v72, v73
    v_cvt_pk_bf16_f32 v53, v74, v75
    v_cvt_pk_bf16_f32 v54, v76, v77
    v_cvt_pk_bf16_f32 v55, v78, v79
    s_lshl_b32 s60, s43, 11
    s_add_u32 s60, s60, 0
    v_add_u32 v12, s60, v4
    ds_write_b128 v12, v[48:51]
    ds_write_b128 v12, v[52:55] offset:1024
    s_waitcnt lgkmcnt(0)
    s_lshl_b32 s60, s43, 2
    s_add_u32 s60, s60, 136208
    v_mov_b32 v14, s60
    v_mov_b32 v15, 1
    ds_write_b32 v14, v15
    s_and_b32 s60, s42, 3
    s_cmp_eq_u32 s60, 3
    s_cbranch_scc1 k1_b_nopair
    v_lshlrev_b32 v14, 4, v3
    v_add_u32 v14, 137984, v14
    ds_read_b128 v[16:19], v14 offset:0
    ds_read_b128 v[20:23], v14 offset:32
    ds_read_b128 v[24:27], v14 offset:64
    ds_read_b128 v[28:31], v14 offset:96
    v_lshlrev_b32 v14, 4, v3
    v_add_u32 v14, 138496, v14
    ds_read_b128 v[32:35], v14 offset:0
    ds_read_b128 v[36:39], v14 offset:32
    ds_read_b128 v[40:43], v14 offset:64
    ds_read_b128 v[44:47], v14 offset:96
    s_waitcnt lgkmcnt(3)
    v_pk_fma_f32 v[16:17], v[16:17], v[6:7], v[32:33] op_sel:[0,1,0] op_sel_hi:[1,1,1] neg_lo:[0,0,1] neg_hi:[0,0,1]
    v_pk_fma_f32 v[96:97], v[96:97], v[6:7], v[16:17] op_sel:[0,0,0] op_sel_hi:[1,0,1] neg_lo:[0,0,1] neg_hi:[0,0,1]
    v_max_f32 v96, 0, v96
    v_max_f32 v97, 0, v97
    v_pk_mul_f32 v[96:97], v[96:97], v[96:97]
    v_pk_fma_f32 v[18:19], v[18:19], v[6:7], v[34:35] op_sel:[0,1,0] op_sel_hi:[1,1,1] neg_lo:[0,0,1] neg_hi:[0,0,1]
    v_pk_fma_f32 v[98:99], v[98:99], v[6:7], v[18:19] op_sel:[0,0,0] op_sel_hi:[1,0,1] neg_lo:[0,0,1] neg_hi:[0,0,1]
    v_max_f32 v98, 0, v98
    v_max_f32 v99, 0, v99
    v_pk_mul_f32 v[98:99], v[98:99], v[98:99]
    s_waitcnt lgkmcnt(2)
    v_pk_fma_f32 v[20:21], v[20:21], v[6:7], v[36:37] op_sel:[0,1,0] op_sel_hi:[1,1,1] neg_lo:[0,0,1] neg_hi:[0,0,1]
    v_pk_fma_f32 v[100:101], v[100:101], v[6:7], v[20:21] op_sel:[0,0,0] op_sel_hi:[1,0,1] neg_lo:[0,0,1] neg_hi:[0,0,1]
    v_max_f32 v100, 0, v100
    v_max_f32 v101, 0, v101
    v_pk_mul_f32 v[100:101], v[100:101], v[100:101]
    v_pk_fma_f32 v[22:23], v[22:23], v[6:7], v[38:39] op_sel:[0,1,0] op_sel_hi:[1,1,1] neg_lo:[0,0,1] neg_hi:[0,0,1]
    v_pk_fma_f32 v[102:103], v[102:103], v[6:7], v[22:23] op_sel:[0,0,0] op_sel_hi:[1,0,1] neg_lo:[0,0,1] neg_hi:[0,0,1]
    v_max_f32 v102, 0, v102
    v_max_f32 v103, 0, v103
    v_pk_mul_f32 v[102:103], v[102:103], v[102:103]
    s_waitcnt lgkmcnt(1)
    v_pk_fma_f32 v[24:25], v[24:25], v[6:7], v[40:41] op_sel:[0,1,0] op_sel_hi:[1,1,1] neg_lo:[0,0,1] neg_hi:[0,0,1]
    v_pk_fma_f32 v[104:105], v[104:105], v[6:7], v[24:25] op_sel:[0,0,0] op_sel_hi:[1,0,1] neg_lo:[0,0,1] neg_hi:[0,0,1]
    v_max_f32 v104, 0, v104
    v_max_f32 v105, 0, v105
    v_pk_mul_f32 v[104:105], v[104:105], v[104:105]
    v_pk_fma_f32 v[26:27], v[26:27], v[6:7], v[42:43] op_sel:[0,1,0] op_sel_hi:[1,1,1] neg_lo:[0,0,1] neg_hi:[0,0,1]
    v_pk_fma_f32 v[106:107], v[106:107], v[6:7], v[26:27] op_sel:[0,0,0] op_sel_hi:[1,0,1] neg_lo:[0,0,1] neg_hi:[0,0,1]
    v_max_f32 v106, 0, v106
    v_max_f32 v107, 0, v107
    v_pk_mul_f32 v[106:107], v[106:107], v[106:107]
    s_waitcnt lgkmcnt(0)
    v_pk_fma_f32 v[28:29], v[28:29], v[6:7], v[44:45] op_sel:[0,1,0] op_sel_hi:[1,1,1] neg_lo:[0,0,1] neg_hi:[0,0,1]
    v_pk_fma_f32 v[108:109], v[108:109], v[6:7], v[28:29] op_sel:[0,0,0] op_sel_hi:[1,0,1] neg_lo:[0,0,1] neg_hi:[0,0,1]
    v_max_f32 v108, 0, v108
    v_max_f32 v109, 0, v109
    v_pk_mul_f32 v[108:109], v[108:109], v[108:109]
    v_pk_fma_f32 v[30:31], v[30:31], v[6:7], v[46:47] op_sel:[0,1,0] op_sel_hi:[1,1,1] neg_lo:[0,0,1] neg_hi:[0,0,1]
    v_pk_fma_f32 v[110:111], v[110:111], v[6:7], v[30:31] op_sel:[0,0,0] op_sel_hi:[1,0,1] neg_lo:[0,0,1] neg_hi:[0,0,1]
    v_max_f32 v110, 0, v110
    v_max_f32 v111, 0, v111
    v_pk_mul_f32 v[110:111], v[110:111], v[110:111]
    v_cvt_pk_bf16_f32 v208, v96, v97
    v_cvt_pk_bf16_f32 v209, v98, v99
    v_cvt_pk_bf16_f32 v210, v100, v101
    v_cvt_pk_bf16_f32 v211, v102, v103
    v_cvt_pk_bf16_f32 v212, v104, v105
    v_cvt_pk_bf16_f32 v213, v106, v107
    v_cvt_pk_bf16_f32 v214, v108, v109
    v_cvt_pk_bf16_f32 v215, v110, v111
    s_mul_i32 s60, s49, 144
    s_lshl_b32 s61, s45, 1
    s_add_u32 s60, s60, s61
    s_add_u32 s60, s60, 4
    s_lshl_b32 s60, s60, 10
    buffer_store_dwordx4 v[208:211], v4, s[36:39], s60 offen sc1
    buffer_store_dwordx4 v[212:215], v4, s[36:39], s60 offen offset:1024 sc1
    v_lshlrev_b32 v14, 4, v3
    v_add_u32 v14, 138112, v14
    ds_read_b128 v[16:19], v14 offset:0
    ds_read_b128 v[20:23], v14 offset:32
    ds_read_b128 v[24:27], v14 offset:64
    ds_read_b128 v[28:31], v14 offset:96
    v_lshlrev_b32 v14, 4, v3
    v_add_u32 v14, 138624, v14
    ds_read_b128 v[32:35], v14 offset:0
    ds_read_b128 v[36:39], v14 offset:32
    ds_read_b128 v[40:43], v14 offset:64
    ds_read_b128 v[44:47], v14 offset:96
    s_waitcnt lgkmcnt(3)
    v_pk_fma_f32 v[16:17], v[16:17], v[6:7], v[32:33] op_sel:[0,1,0] op_sel_hi:[1,1,1] neg_lo:[0,0,1] neg_hi:[0,0,1]
    v_pk_fma_f32 v[112:113], v[112:113], v[6:7], v[16:17] op_sel:[0,0,0] op_sel_hi:[1,0,1] neg_lo:[0,0,1] neg_hi:[0,0,1]
    v_max_f32 v112, 0, v112
    v_max_f32 v113, 0, v113
    v_pk_mul_f32 v[112:113], v[112:113], v[112:113]
    v_pk_fma_f32 v[18:19], v[18:19], v[6:7], v[34:35] op_sel:[0,1,0] op_sel_hi:[1,1,1] neg_lo:[0,0,1] neg_hi:[0,0,1]
    v_pk_fma_f32 v[114:115], v[114:115], v[6:7], v[18:19] op_sel:[0,0,0] op_sel_hi:[1,0,1] neg_lo:[0,0,1] neg_hi:[0,0,1]
    v_max_f32 v114, 0, v114
    v_max_f32 v115, 0, v115
    v_pk_mul_f32 v[114:115], v[114:115], v[114:115]
    s_waitcnt lgkmcnt(2)
    v_pk_fma_f32 v[20:21], v[20:21], v[6:7], v[36:37] op_sel:[0,1,0] op_sel_hi:[1,1,1] neg_lo:[0,0,1] neg_hi:[0,0,1]
    v_pk_fma_f32 v[116:117], v[116:117], v[6:7], v[20:21] op_sel:[0,0,0] op_sel_hi:[1,0,1] neg_lo:[0,0,1] neg_hi:[0,0,1]
    v_max_f32 v116, 0, v116
    v_max_f32 v117, 0, v117
    v_pk_mul_f32 v[116:117], v[116:117], v[116:117]
    v_pk_fma_f32 v[22:23], v[22:23], v[6:7], v[38:39] op_sel:[0,1,0] op_sel_hi:[1,1,1] neg_lo:[0,0,1] neg_hi:[0,0,1]
    v_pk_fma_f32 v[118:119], v[118:119], v[6:7], v[22:23] op_sel:[0,0,0] op_sel_hi:[1,0,1] neg_lo:[0,0,1] neg_hi:[0,0,1]
    v_max_f32 v118, 0, v118
    v_max_f32 v119, 0, v119
    v_pk_mul_f32 v[118:119], v[118:119], v[118:119]
    s_waitcnt lgkmcnt(1)
    v_pk_fma_f32 v[24:25], v[24:25], v[6:7], v[40:41] op_sel:[0,1,0] op_sel_hi:[1,1,1] neg_lo:[0,0,1] neg_hi:[0,0,1]
    v_pk_fma_f32 v[120:121], v[120:121], v[6:7], v[24:25] op_sel:[0,0,0] op_sel_hi:[1,0,1] neg_lo:[0,0,1] neg_hi:[0,0,1]
    v_max_f32 v120, 0, v120
    v_max_f32 v121, 0, v121
    v_pk_mul_f32 v[120:121], v[120:121], v[120:121]
    v_pk_fma_f32 v[26:27], v[26:27], v[6:7], v[42:43] op_sel:[0,1,0] op_sel_hi:[1,1,1] neg_lo:[0,0,1] neg_hi:[0,0,1]
    v_pk_fma_f32 v[122:123], v[122:123], v[6:7], v[26:27] op_sel:[0,0,0] op_sel_hi:[1,0,1] neg_lo:[0,0,1] neg_hi:[0,0,1]
    v_max_f32 v122, 0, v122
    v_max_f32 v123, 0, v123
    v_pk_mul_f32 v[122:123], v[122:123], v[122:123]
    s_waitcnt lgkmcnt(0)
    v_pk_fma_f32 v[28:29], v[28:29], v[6:7], v[44:45] op_sel:[0,1,0] op_sel_hi:[1,1,1] neg_lo:[0,0,1] neg_hi:[0,0,1]
    v_pk_fma_f32 v[124:125], v[124:125], v[6:7], v[28:29] op_sel:[0,0,0] op_sel_hi:[1,0,1] neg_lo:[0,0,1] neg_hi:[0,0,1]
    v_max_f32 v124, 0, v124
    v_max_f32 v125, 0, v125
    v_pk_mul_f32 v[124:125], v[124:125], v[124:125]
    v_pk_fma_f32 v[30:31], v[30:31], v[6:7], v[46:47] op_sel:[0,1,0] op_sel_hi:[1,1,1] neg_lo:[0,0,1] neg_hi:[0,0,1]
    v_pk_fma_f32 v[126:127], v[126:127], v[6:7], v[30:31] op_sel:[0,0,0] op_sel_hi:[1,0,1] neg_lo:[0,0,1] neg_hi:[0,0,1]
    v_max_f32 v126, 0, v126
    v_max_f32 v127, 0, v127
    v_pk_mul_f32 v[126:127], v[126:127], v[126:127]
    v_cvt_pk_bf16_f32 v216, v112, v113
    v_cvt_pk_bf16_f32 v217, v114, v115
    v_cvt_pk_bf16_f32 v218, v116, v117
    v_cvt_pk_bf16_f32 v219, v118, v119
    v_cvt_pk_bf16_f32 v220, v120, v121
    v_cvt_pk_bf16_f32 v221, v122, v123
    v_cvt_pk_bf16_f32 v222, v124, v125
    v_cvt_pk_bf16_f32 v223, v126, v127
    s_mul_i32 s60, s49, 144
    s_lshl_b32 s61, s45, 1
    s_add_u32 s60, s60, s61
    s_add_u32 s60, s60, 6
    s_lshl_b32 s60, s60, 10
    buffer_store_dwordx4 v[216:219], v4, s[36:39], s60 offen sc1
    buffer_store_dwordx4 v[220:223], v4, s[36:39], s60 offen offset:1024 sc1
k1_b_nopair:
    s_nop 15
    s_nop 3
    v_lshlrev_b32 v14, 4, v3
    v_add_u32 v14, 137472, v14
    ds_read_b128 v[16:19], v14 offset:0
    ds_read_b128 v[20:23], v14 offset:32
    ds_read_b128 v[24:27], v14 offset:64
    ds_read_b128 v[28:31], v14 offset:96
    s_waitcnt lgkmcnt(3)
    v_pk_mul_f32 v[16:17], v[16:17], v[6:7] op_sel:[0,1] op_sel_hi:[1,1]
    v_pk_fma_f32 v[80:81], v[80:81], v[6:7], v[16:17] op_sel:[0,0,0] op_sel_hi:[1,0,1] neg_lo:[0,0,1] neg_hi:[0,0,1]
    v_pk_mul_f32 v[18:19], v[18:19], v[6:7] op_sel:[0,1] op_sel_hi:[1,1]
    v_pk_fma_f32 v[82:83], v[82:83], v[6:7], v[18:19] op_sel:[0,0,0] op_sel_hi:[1,0,1] neg_lo:[0,0,1] neg_hi:[0,0,1]
    s_waitcnt lgkmcnt(2)
    v_pk_mul_f32 v[20:21], v[20:21], v[6:7] op_sel:[0,1] op_sel_hi:[1,1]
    v_pk_fma_f32 v[84:85], v[84:85], v[6:7], v[20:21] op_sel:[0,0,0] op_sel_hi:[1,0,1] neg_lo:[0,0,1] neg_hi:[0,0,1]
    v_pk_mul_f32 v[22:23], v[22:23], v[6:7] op_sel:[0,1] op_sel_hi:[1,1]
    v_pk_fma_f32 v[86:87], v[86:87], v[6:7], v[22:23] op_sel:[0,0,0] op_sel_hi:[1,0,1] neg_lo:[0,0,1] neg_hi:[0,0,1]
    s_waitcnt lgkmcnt(1)
    v_pk_mul_f32 v[24:25], v[24:25], v[6:7] op_sel:[0,1] op_sel_hi:[1,1]
    v_pk_fma_f32 v[88:89], v[88:89], v[6:7], v[24:25] op_sel:[0,0,0] op_sel_hi:[1,0,1] neg_lo:[0,0,1] neg_hi:[0,0,1]
    v_pk_mul_f32 v[26:27], v[26:27], v[6:7] op_sel:[0,1] op_sel_hi:[1,1]
    v_pk_fma_f32 v[90:91], v[90:91], v[6:7], v[26:27] op_sel:[0,0,0] op_sel_hi:[1,0,1] neg_lo:[0,0,1] neg_hi:[0,0,1]
    s_waitcnt lgkmcnt(0)
    v_pk_mul_f32 v[28:29], v[28:29], v[6:7] op_sel:[0,1] op_sel_hi:[1,1]
    v_pk_fma_f32 v[92:93], v[92:93], v[6:7], v[28:29] op_sel:[0,0,0] op_sel_hi:[1,0,1] neg_lo:[0,0,1] neg_hi:[0,0,1]
    v_pk_mul_f32 v[30:31], v[30:31], v[6:7] op_sel:[0,1] op_sel_hi:[1,1]
    v_pk_fma_f32 v[94:95], v[94:95], v[6:7], v[30:31] op_sel:[0,0,0] op_sel_hi:[1,0,1] neg_lo:[0,0,1] neg_hi:[0,0,1]
    v_cvt_pk_bf16_f32 v32, v80, v81
    v_cvt_pk_bf16_f32 v33, v82, v83
    v_cvt_pk_bf16_f32 v34, v84, v85
    v_cvt_pk_bf16_f32 v35, v86, v87
    v_cvt_pk_bf16_f32 v36, v88, v89
    v_cvt_pk_bf16_f32 v37, v90, v91
    v_cvt_pk_bf16_f32 v38, v92, v93
    v_cvt_pk_bf16_f32 v39, v94, v95
    v_mfma_f32_32x32x16_bf16 v[64:79], v[56:59], v[32:35], 0
    s_nop 0
    v_mfma_f32_32x32x16_bf16 v[64:79], v[60:63], v[36:39], v[64:79]
    s_nop 11
    v_max3_f32 v40, v64, v65, v66
    v_min3_f32 v41, v64, v65, v66
    v_max3_f32 v40, v40, v67, v68
    v_min3_f32 v41, v41, v67, v68
    v_max3_f32 v40, v40, v69, v70
    v_min3_f32 v41, v41, v69, v70
    v_max3_f32 v40, v40, v71, v72
    v_min3_f32 v41, v41, v71, v72
    v_max3_f32 v40, v40, v73, v74
    v_min3_f32 v41, v41, v73, v74
    v_max3_f32 v40, v40, v75, v76
    v_min3_f32 v41, v41, v75, v76
    v_max3_f32 v40, v40, v77, v78
    v_min3_f32 v41, v41, v77, v78
    v_max_f32 v40, v40, v79
    v_min_f32 v41, v41, v79
    v_mul_f32 v40, s47, v40
    v_mul_f32 v41, s47, v41
    v_fma_f32 v16, v64, s47, -v40
    v_fma_f32 v80, -v64, s47, v41
    v_fma_f32 v17, v65, s47, -v40
    v_fma_f32 v81, -v65, s47, v41
    v_fma_f32 v18, v66, s47, -v40
    v_fma_f32 v82, -v66, s47, v41
    v_fma_f32 v19, v67, s47, -v40
    v_fma_f32 v83, -v67, s47, v41
    v_fma_f32 v20, v68, s47, -v40
    v_fma_f32 v84, -v68, s47, v41
    v_fma_f32 v21, v69, s47, -v40
    v_fma_f32 v85, -v69, s47, v41
    v_fma_f32 v22, v70, s47, -v40
    v_fma_f32 v86, -v70, s47, v41
    v_fma_f32 v23, v71, s47, -v40
    v_fma_f32 v87, -v71, s47, v41
    v_fma_f32 v24, v72, s47, -v40
    v_fma_f32 v88, -v72, s47, v41
    v_fma_f32 v25, v73, s47, -v40
    v_fma_f32 v89, -v73, s47, v41
    v_fma_f32 v26, v74, s47, -v40
    v_fma_f32 v90, -v74, s47, v41
    v_fma_f32 v27, v75, s47, -v40
    v_fma_f32 v91, -v75, s47, v41
    v_fma_f32 v28, v76, s47, -v40
    v_fma_f32 v92, -v76, s47, v41
    v_fma_f32 v29, v77, s47, -v40
    v_fma_f32 v93, -v77, s47, v41
    v_fma_f32 v30, v78, s47, -v40
    v_fma_f32 v94, -v78, s47, v41
    v_fma_f32 v31, v79, s47, -v40
    v_fma_f32 v95, -v79, s47, v41
    v_exp_f32 v16, v16
    v_exp_f32 v80, v80
    v_exp_f32 v17, v17
    v_exp_f32 v81, v81
    v_exp_f32 v18, v18
    v_exp_f32 v82, v82
    v_exp_f32 v19, v19
    v_exp_f32 v83, v83
    v_exp_f32 v20, v20
    v_exp_f32 v84, v84
    v_exp_f32 v21, v21
    v_exp_f32 v85, v85
    v_exp_f32 v22, v22
    v_exp_f32 v86, v86
    v_exp_f32 v23, v23
    v_exp_f32 v87, v87
    v_exp_f32 v24, v24
    v_exp_f32 v88, v88
    v_exp_f32 v25, v25
    v_exp_f32 v89, v89
    v_exp_f32 v26, v26
    v_exp_f32 v90, v90
    v_exp_f32 v27, v27
    v_exp_f32 v91, v91
    v_exp_f32 v28, v28
    v_exp_f32 v92, v92
    v_exp_f32 v29, v29
    v_exp_f32 v93, v93
    v_exp_f32 v30, v30
    v_exp_f32 v94, v94
    v_exp_f32 v31, v31
    v_exp_f32 v95, v95
    v_pk_add_f32 v[42:43], v[16:17], v[18:19]
    v_pk_add_f32 v[42:43], v[42:43], v[20:21]
    v_pk_add_f32 v[42:43], v[42:43], v[22:23]
    v_pk_add_f32 v[42:43], v[42:43], v[24:25]
    v_pk_add_f32 v[42:43], v[42:43], v[26:27]
    v_pk_add_f32 v[42:43], v[42:43], v[28:29]
    v_pk_add_f32 v[42:43], v[42:43], v[30:31]
    v_add_f32 v42, v42, v43
    v_pk_add_f32 v[44:45], v[80:81], v[82:83]
    v_pk_add_f32 v[44:45], v[44:45], v[84:85]
    v_pk_add_f32 v[44:45], v[44:45], v[86:87]
    v_pk_add_f32 v[44:45], v[44:45], v[88:89]
    v_pk_add_f32 v[44:45], v[44:45], v[90:91]
    v_pk_add_f32 v[44:45], v[44:45], v[92:93]
    v_pk_add_f32 v[44:45], v[44:45], v[94:95]
    v_add_f32 v44, v44, v45
    v_rcp_f32 v42, v42
    v_rcp_f32 v44, v44
    v_pk_mul_f32 v[16:17], v[16:17], v[42:43] op_sel_hi:[1,0]
    v_pk_mul_f32 v[80:81], v[80:81], v[44:45] op_sel_hi:[1,0]
    v_pk_mul_f32 v[18:19], v[18:19], v[42:43] op_sel_hi:[1,0]
    v_pk_mul_f32 v[82:83], v[82:83], v[44:45] op_sel_hi:[1,0]
    v_pk_mul_f32 v[20:21], v[20:21], v[42:43] op_sel_hi:[1,0]
    v_pk_mul_f32 v[84:85], v[84:85], v[44:45] op_sel_hi:[1,0]
    v_pk_mul_f32 v[22:23], v[22:23], v[42:43] op_sel_hi:[1,0]
    v_pk_mul_f32 v[86:87], v[86:87], v[44:45] op_sel_hi:[1,0]
    v_pk_mul_f32 v[24:25], v[24:25], v[42:43] op_sel_hi:[1,0]
    v_pk_mul_f32 v[88:89], v[88:89], v[44:45] op_sel_hi:[1,0]
    v_pk_mul_f32 v[26:27], v[26:27], v[42:43] op_sel_hi:[1,0]
    v_pk_mul_f32 v[90:91], v[90:91], v[44:45] op_sel_hi:[1,0]
    v_pk_mul_f32 v[28:29], v[28:29], v[42:43] op_sel_hi:[1,0]
    v_pk_mul_f32 v[92:93], v[92:93], v[44:45] op_sel_hi:[1,0]
    v_pk_mul_f32 v[30:31], v[30:31], v[42:43] op_sel_hi:[1,0]
    v_pk_mul_f32 v[94:95], v[94:95], v[44:45] op_sel_hi:[1,0]
    v_cvt_pk_bf16_f32 v48, v16, v17
    v_cvt_pk_bf16_f32 v49, v18, v19
    v_cvt_pk_bf16_f32 v50, v20, v21
    v_cvt_pk_bf16_f32 v51, v22, v23
    v_cvt_pk_bf16_f32 v52, v24, v25
    v_cvt_pk_bf16_f32 v53, v26, v27
    v_cvt_pk_bf16_f32 v54, v28, v29
    v_cvt_pk_bf16_f32 v55, v30, v31
    v_cvt_pk_bf16_f32 v56, v80, v81
    v_cvt_pk_bf16_f32 v57, v82, v83
    v_cvt_pk_bf16_f32 v58, v84, v85
    v_cvt_pk_bf16_f32 v59, v86, v87
    v_cvt_pk_bf16_f32 v60, v88, v89
    v_cvt_pk_bf16_f32 v61, v90, v91
    v_cvt_pk_bf16_f32 v62, v92, v93
    v_cvt_pk_bf16_f32 v63, v94, v95
    s_waitcnt vmcnt(0)
    v_mov_b32 v14, 136236
    v_mov_b32 v15, 1
    s_mov_b64 exec, 1
    ds_add_rtn_u32 v15, v14, v15
    s_waitcnt lgkmcnt(0)
    s_mov_b64 exec, -1
    v_readfirstlane_b32 s61, v15
    s_nop 0
    s_cmp_lg_u32 s61, 7
    s_cbranch_scc1 k1_hdB
    s_lshl_b32 s61, s41, 7
    s_lshl_b32 s60, s42, 2
    s_add_u32 s61, s61, s60
    s_add_u32 s61, s61, 15208448
    v_mov_b32 v14, s61
    v_mov_b32 v15, 1
    s_mov_b64 exec, 1
    buffer_store_dword v15, v14, s[36:39], 0 offen sc1
    s_mov_b64 exec, -1
k1_hdB:
    s_cmp_lg_u32 s43, 0
    s_cbranch_scc1 k1_waitflag
    v_and_b32 v14, 15, v1
    v_lshlrev_b32 v14, 2, v14
    s_lshl_b32 s62, s42, 7
    s_add_u32 s62, s62, 15204352
    s_lshl_b32 s60, s42, 4
    v_mov_b32 v12, s60
    s_mov_b32 s61, 0
    v_cmp_gt_u32 s[64:65], 16, v149
    s_branch k1_poll2
k1_poll:
    buffer_load_dword v11, v12, s[32:35], 0 offen sc1
    s_waitcnt vmcnt(0)
    v_cmp_gt_u32 s[64:65], 16, v11
    s_add_u32 s61, s61, 1
k1_poll2:
    s_cmp_ge_u32 s61, 0x400000
    s_cbranch_scc1 k1_pollok
    s_cmp_lg_u64 s[64:65], 0
    s_cbranch_scc1 k1_poll
    buffer_load_dword v10, v14, s[36:39], s62 offen sc1
    s_waitcnt vmcnt(0)
    v_cmp_ne_u32 vcc, 1, v10
    s_add_u32 s61, s61, 1
    s_cmp_eq_u64 vcc, 0
    s_cbranch_scc1 k1_pollok
    s_sleep 4
    s_cmp_lt_u32 s61, 0x400000
    s_cbranch_scc1 k1_poll2
k1_pollok:
    v_mov_b32 v14, 136232
    v_mov_b32 v15, 1
    ds_write_b32 v14, v15
    s_branch k1_polled
k1_waitflag:
    v_mov_b32 v14, 136232
    s_mov_b32 s61, 0
k1_sp2:
    ds_read_b32 v15, v14
    s_waitcnt lgkmcnt(0)
    v_readfirstlane_b32 s60, v15
    s_add_u32 s61, s61, 1
    s_cmp_ge_u32 s60, 1
    s_cbranch_scc1 k1_sp2d
    s_cmp_lt_u32 s61, 0x400000
    s_cbranch_scc1 k1_sp2
k1_sp2d:
k1_polled:
    s_lshl_b32 s60, s42, 16
    s_lshl_b32 s61, s43, 10
    s_add_u32 s60, s60, s61
    s_add_u32 s60, s60, 13631488
    s_lshl_b32 s61, s42, 12
    s_add_u32 s61, s61, 14680064
    buffer_load_dwordx4 v[30:33], v4, s[36:39], s61 offen offset:0 sc1
    buffer_load_dwordx4 v[34:37], v4, s[36:39], s61 offen offset:1024 sc1
    buffer_load_dwordx4 v[38:41], v4, s[36:39], s61 offen offset:2048 sc1
    buffer_load_dwordx4 v[42:45], v4, s[36:39], s61 offen offset:3072 sc1
    buffer_load_dwordx4 v[192:195], v4, s[36:39], s60 offen sc1
    s_add_u32 s60, s60, 4096
    buffer_load_dwordx4 v[196:199], v4, s[36:39], s60 offen sc1
    s_add_u32 s60, s60, 4096
    buffer_load_dwordx4 v[200:203], v4, s[36:39], s60 offen sc1
    s_add_u32 s60, s60, 4096
    buffer_load_dwordx4 v[204:207], v4, s[36:39], s60 offen sc1
    s_add_u32 s60, s60, 4096
    buffer_load_dwordx4 v[208:211], v4, s[36:39], s60 offen sc1
    s_add_u32 s60, s60, 4096
    buffer_load_dwordx4 v[212:215], v4, s[36:39], s60 offen sc1
    s_add_u32 s60, s60, 4096
    buffer_load_dwordx4 v[216:219], v4, s[36:39], s60 offen sc1
    s_add_u32 s60, s60, 4096
    buffer_load_dwordx4 v[220:223], v4, s[36:39], s60 offen sc1
    s_add_u32 s60, s60, 4096
    buffer_load_dwordx4 v[224:227], v4, s[36:39], s60 offen sc1
    s_add_u32 s60, s60, 4096
    buffer_load_dwordx4 v[228:231], v4, s[36:39], s60 offen sc1
    s_add_u32 s60, s60, 4096
    buffer_load_dwordx4 v[232:235], v4, s[36:39], s60 offen sc1
    s_add_u32 s60, s60, 4096
    buffer_load_dwordx4 v[236:239], v4, s[36:39], s60 offen sc1
    s_add_u32 s60, s60, 4096
    buffer_load_dwordx4 v[240:243], v4, s[36:39], s60 offen sc1
    s_add_u32 s60, s60, 4096
    buffer_load_dwordx4 v[244:247], v4, s[36:39], s60 offen sc1
    s_add_u32 s60, s60, 4096
    buffer_load_dwordx4 v[248:251], v4, s[36:39], s60 offen sc1
    s_add_u32 s60, s60, 4096
    buffer_load_dwordx4 v[252:255], v4, s[36:39], s60 offen sc1
    s_add_u32 s60, s60, 4096
    s_waitcnt vmcnt(18)
    v_add_f32 v30, v30, v34
    s_waitcnt vmcnt(16)
    v_add_f32 v38, v38, v42
    v_add_f32 v30, v30, v38
    v_add_f32 v31, v31, v35
    v_add_f32 v39, v39, v43
    v_add_f32 v31, v31, v39
    v_add_f32 v32, v32, v36
    v_add_f32 v40, v40, v44
    v_add_f32 v32, v32, v40
    v_add_f32 v33, v33, v37
    v_add_f32 v41, v41, v45
    v_add_f32 v33, v33, v41
    v_mov_b32 v34, v30
    v_mov_b32 v35, v31
    v_mov_b32 v36, v32
    v_mov_b32 v37, v33
    v_permlane32_swap_b32 v30, v34
    v_add_f32 v30, v30, v34
    v_permlane32_swap_b32 v31, v35
    v_add_f32 v31, v31, v35
    v_permlane32_swap_b32 v32, v36
    v_add_f32 v32, v32, v36
    v_permlane32_swap_b32 v33, v37
    v_add_f32 v33, v33, v37
    v_mov_b32 v34, v30
    v_mov_b32 v35, v31
    v_mov_b32 v36, v32
    v_mov_b32 v37, v33
    v_permlane16_swap_b32 v30, v34
    v_add_f32 v30, v30, v34
    v_permlane16_swap_b32 v31, v35
    v_add_f32 v31, v31, v35
    v_permlane16_swap_b32 v32, v36
    v_add_f32 v32, v32, v36
    v_permlane16_swap_b32 v33, v37
    v_add_f32 v33, v33, v37
    v_cvt_pk_bf16_f32 v36, v30, v31
    v_cvt_pk_bf16_f32 v37, v32, v33
    v_and_b32 v38, 15, v1
    v_lshrrev_b32 v39, 3, v38
    v_lshlrev_b32 v39, 5, v39
    v_lshrrev_b32 v40, 2, v38
    v_and_b32 v40, 1, v40
    v_lshlrev_b32 v40, 6, v40
    v_add_u32 v39, v39, v40
    v_and_b32 v40, 3, v38
    v_lshlrev_b32 v40, 3, v40
    v_add_u32 v39, v39, v40
    s_lshl_b32 s60, s43, 7
    s_add_u32 s60, s60, 142336
    v_add_u32 v39, s60, v39
    ds_write_b64 v39, v[36:37]
    s_waitcnt vmcnt(7)
    v_pk_add_f32 v[192:193], v[192:193], v[224:225]
    v_pk_add_f32 v[194:195], v[194:195], v[226:227]
    s_waitcnt vmcnt(6)
    v_pk_add_f32 v[196:197], v[196:197], v[228:229]
    v_pk_add_f32 v[198:199], v[198:199], v[230:231]
    s_waitcnt vmcnt(5)
    v_pk_add_f32 v[200:201], v[200:201], v[232:233]
    v_pk_add_f32 v[202:203], v[202:203], v[234:235]
    s_waitcnt vmcnt(4)
    v_pk_add_f32 v[204:205], v[204:205], v[236:237]
    v_pk_add_f32 v[206:207], v[206:207], v[238:239]
    s_waitcnt vmcnt(3)
    v_pk_add_f32 v[208:209], v[208:209], v[240:241]
    v_pk_add_f32 v[210:211], v[210:211], v[242:243]
    s_waitcnt vmcnt(2)
    v_pk_add_f32 v[212:213], v[212:213], v[244:245]
    v_pk_add_f32 v[214:215], v[214:215], v[246:247]
    s_waitcnt vmcnt(1)
    v_pk_add_f32 v[216:217], v[216:217], v[248:249]
    v_pk_add_f32 v[218:219], v[218:219], v[250:251]
    s_waitcnt vmcnt(0)
    v_pk_add_f32 v[220:221], v[220:221], v[252:253]
    v_pk_add_f32 v[222:223], v[222:223], v[254:255]
    v_pk_add_f32 v[192:193], v[192:193], v[208:209]
    v_pk_add_f32 v[194:195], v[194:195], v[210:211]
    v_pk_add_f32 v[196:197], v[196:197], v[212:213]
    v_pk_add_f32 v[198:199], v[198:199], v[214:215]
    v_pk_add_f32 v[200:201], v[200:201], v[216:217]
    v_pk_add_f32 v[202:203], v[202:203], v[218:219]
    v_pk_add_f32 v[204:205], v[204:205], v[220:221]
    v_pk_add_f32 v[206:207], v[206:207], v[222:223]
    v_pk_add_f32 v[192:193], v[192:193], v[200:201]
    v_pk_add_f32 v[194:195], v[194:195], v[202:203]
    v_pk_add_f32 v[196:197], v[196:197], v[204:205]
    v_pk_add_f32 v[198:199], v[198:199], v[206:207]
    v_pk_add_f32 v[192:193], v[192:193], v[196:197]
    v_pk_add_f32 v[194:195], v[194:195], v[198:199]
    v_cvt_pk_bf16_f32 v200, v192, v193
    v_cvt_pk_bf16_f32 v201, v194, v195
    s_lshl_b32 s60, s43, 4
    s_add_u32 s60, s60, 140288
    v_lshlrev_b32 v39, 6, v2
    v_lshlrev_b32 v38, 3, v3
    v_add_u32 v39, v39, v38
    v_add_u32 v39, s60, v39
    ds_write_b64 v39, v[200:201]
    s_waitcnt lgkmcnt(0)
    v_mov_b32 v14, 136196
    v_mov_b32 v15, 1
    s_mov_b64 exec, 1
    ds_add_u32 v14, v15
    s_mov_b64 exec, -1
    s_mov_b32 s61, 0
k1_sp3:
    ds_read_b32 v15, v14
    s_waitcnt lgkmcnt(0)
    v_readfirstlane_b32 s60, v15
    s_add_u32 s61, s61, 1
    s_cmp_ge_u32 s60, 4
    s_cbranch_scc1 k1_sp3d
    s_cmp_lt_u32 s61, 0x400000
    s_cbranch_scc1 k1_sp3
k1_sp3d:
    v_lshrrev_b32 v30, 2, v2
    v_and_b32 v30, 1, v30
    v_lshrrev_b32 v31, 3, v2
    v_lshlrev_b32 v31, 2, v31
    v_and_b32 v32, 3, v2
    v_add_u32 v31, v31, v32
    v_lshlrev_b32 v32, 4, v30
    v_add_u32 v31, v31, v32
    v_lshlrev_b32 v31, 6, v31
    v_add_u32 v31, 140288, v31
    s_lshl_b32 s60, s43, 7
    s_add_u32 s60, s60, 142336
    v_lshlrev_b32 v32, 6, v3
    v_add_u32 v32, s60, v32
    v_mov_b32 v33, 136256
    v_cmp_eq_u32 vcc, v30, v3
    s_nop 1
    v_cndmask_b32 v31, v33, v31, vcc
    v_cndmask_b32 v32, v33, v32, vcc
    ds_read_b128 v[192:195], v31 offset:0
    ds_read_b128 v[208:211], v32 offset:0
    ds_read_b128 v[196:199], v31 offset:16
    ds_read_b128 v[212:215], v32 offset:16
    ds_read_b128 v[200:203], v31 offset:32
    ds_read_b128 v[216:219], v32 offset:32
    ds_read_b128 v[204:207], v31 offset:48
    ds_read_b128 v[220:223], v32 offset:48
    s_waitcnt lgkmcnt(7)
    v_mfma_f32_32x32x16_bf16 v[224:239], v[192:195], v[48:51], 0
    s_waitcnt lgkmcnt(6)
    v_mfma_f32_32x32x16_bf16 v[240:255], v[208:211], v[48:51], 0
    s_waitcnt lgkmcnt(5)
    v_mfma_f32_32x32x16_bf16 v[224:239], v[196:199], v[52:55], v[224:239]
    s_waitcnt lgkmcnt(4)
    v_mfma_f32_32x32x16_bf16 v[240:255], v[212:215], v[52:55], v[240:255]
    s_waitcnt lgkmcnt(3)
    v_mfma_f32_32x32x16_bf16 v[224:239], v[200:203], v[56:59], v[224:239]
    s_waitcnt lgkmcnt(2)
    v_mfma_f32_32x32x16_bf16 v[240:255], v[216:219], v[56:59], v[240:255]
    s_waitcnt lgkmcnt(1)
    v_mfma_f32_32x32x16_bf16 v[224:239], v[204:207], v[60:63], v[224:239]
    s_waitcnt lgkmcnt(0)
    v_mfma_f32_32x32x16_bf16 v[240:255], v[220:223], v[60:63], v[240:255]
    s_nop 11
    v_add_f32 v30, 0x358637bd, v240
    v_rcp_f32 v30, v30
    s_nop 0
    v_mul_f32 v224, v224, v30
    v_mul_f32 v225, v225, v30
    v_mul_f32 v226, v226, v30
    v_mul_f32 v227, v227, v30
    v_mul_f32 v228, v228, v30
    v_mul_f32 v229, v229, v30
    v_mul_f32 v230, v230, v30
    v_mul_f32 v231, v231, v30
    v_mul_f32 v232, v232, v30
    v_mul_f32 v233, v233, v30
    v_mul_f32 v234, v234, v30
    v_mul_f32 v235, v235, v30
    v_mul_f32 v236, v236, v30
    v_mul_f32 v237, v237, v30
    v_mul_f32 v238, v238, v30
    v_mul_f32 v239, v239, v30
    v_cvt_pk_bf16_f32 v34, v224, v225
    v_cvt_pk_bf16_f32 v35, v226, v227
    v_cvt_pk_bf16_f32 v36, v228, v229
    v_cvt_pk_bf16_f32 v37, v230, v231
    v_cvt_pk_bf16_f32 v38, v232, v233
    v_cvt_pk_bf16_f32 v39, v234, v235
    v_cvt_pk_bf16_f32 v40, v236, v237
    v_cvt_pk_bf16_f32 v41, v238, v239
    s_mul_i32 s60, s49, 144
    s_lshl_b32 s61, s42, 1
    s_add_u32 s60, s60, s61
    s_add_u32 s60, s60, 112
    s_lshl_b32 s60, s60, 10
    buffer_store_dwordx4 v[34:37], v4, s[36:39], s60 offen sc1
    buffer_store_dwordx4 v[38:41], v4, s[36:39], s60 offen offset:1024 sc1
    s_and_b32 s64, s2, 7
    s_lshl_b32 s64, s64, 2
    s_lshr_b32 s65, s2, 6
    s_add_u32 s64, s64, s65
    s_lshr_b32 s65, s2, 3
    s_and_b32 s65, s65, 7
    s_lshl_b32 s64, s64, 1
    s_lshl_b32 s65, s65, 1
    s_lshr_b32 s68, s40, 1
    s_add_u32 s68, s68, 2
    s_and_b32 s68, s68, 3
    s_and_b32 s69, s68, 1
    s_add_u32 s70, s64, s69
    s_add_u32 s71, s65, s69
    s_cmp_ge_u32 s68, 2
    s_cselect_b32 s70, s71, s70
    s_cselect_b32 s71, 0xa00000, 0
    s_mul_i32 s66, s70, 147456
    s_add_u32 s66, s66, s71
    s_and_b32 s71, s40, 1
    s_mul_i32 s71, s71, 4096
    s_add_u32 s66, s66, s71
    s_mul_i32 s67, s68, 8192
    s_add_u32 s67, s67, s71
    s_load_dwordx4 s[68:71], s[0:1], 64
    s_add_u32 s66, s66, 24576
    s_waitcnt lgkmcnt(0)
    s_barrier
    s_mov_b32 s28, s68
    s_mov_b32 s29, s69
    s_mov_b32 s30, 1024
    s_mov_b32 s31, 0x20000
    s_mov_b32 s16, s70
    s_mov_b32 s17, s71
    s_mov_b32 s18, 0x200000
    s_mov_b32 s19, 0x20000
    s_lshr_b32 s68, s43, 1
    s_and_b32 s69, s43, 1
    s_add_u32 s60, s64, s68
    s_lshl_b32 s60, s60, 5
    v_add_u32 v6, s60, v2
    v_lshlrev_b32 v6, 10, v6
    v_lshlrev_b32 v5, 5, v3
    s_add_u32 s60, s65, s69
    s_lshl_b32 s60, s60, 6
    s_lshl_b32 s61, s44, 4
    s_add_u32 s60, s60, s61
    v_add_u32 v5, s60, v5
    v_add_u32 v6, v6, v5
    s_mul_i32 s60, s68, 8192
    s_mul_i32 s61, s44, 4096
    s_add_u32 s60, s60, s61
    v_add_u32 v16, s60, v4
    s_mul_i32 s60, s69, 8192
    s_add_u32 s60, s60, s61
    s_add_u32 s60, s60, 16384
    v_add_u32 v19, s60, v4
    v_add_u32 v17, 65536, v16
    v_add_u32 v20, 65536, v19
    v_add_u32 v18, 131072, v16
    v_add_u32 v21, 131072, v19
    s_xor_b32 s60, s40, 4
    s_lshl_b32 s60, s60, 12
    v_add_u32 v22, s60, v4
    s_lshl_b32 s60, s40, 12
    v_add_u32 v23, s60, v4
    v_and_b32 v28, 15, v1
    v_lshlrev_b32 v28, 2, v28
    s_lshr_b32 s62, s64, 2
    s_lshl_b32 s62, s62, 7
    s_add_u32 s62, s62, 15212544
    s_waitcnt lgkmcnt(0)
    s_barrier
    ds_read_b128 v[128:131], v16 offset:0
    ds_read_b128 v[132:135], v19 offset:0
    ds_read_b128 v[136:139], v16 offset:1024
    ds_read_b128 v[140:143], v19 offset:1024
    ds_read_b128 v[144:147], v16 offset:2048
    ds_read_b128 v[148:151], v19 offset:2048
    ds_read_b128 v[152:155], v16 offset:3072
    ds_read_b128 v[156:159], v19 offset:3072
    s_add_u32 m0, s67, 98304
    s_nop 0
    buffer_load_dwordx4 v4, s[36:39], s66 offen offset:0 sc1 lds
    buffer_load_dwordx4 v4, s[36:39], s66 offen offset:1024 sc1 lds
    buffer_load_dwordx4 v4, s[36:39], s66 offen offset:2048 sc1 lds
    buffer_load_dwordx4 v4, s[36:39], s66 offen offset:3072 sc1 lds
    s_add_u32 s66, s66, 8192
    s_waitcnt lgkmcnt(0)
    s_barrier
    ds_read_b128 v[160:163], v16 offset:32768
    ds_read_b128 v[164:167], v19 offset:32768
    ds_read_b128 v[168:171], v16 offset:33792
    ds_read_b128 v[172:175], v19 offset:33792
    ds_read_b128 v[176:179], v16 offset:34816
    ds_read_b128 v[180:183], v19 offset:34816
    ds_read_b128 v[184:187], v16 offset:35840
    ds_read_b128 v[188:191], v19 offset:35840
    s_add_u32 m0, s67, 0
    s_nop 0
    buffer_load_dwordx4 v4, s[36:39], s66 offen offset:0 sc1 lds
    buffer_load_dwordx4 v4, s[36:39], s66 offen offset:1024 sc1 lds
    buffer_load_dwordx4 v4, s[36:39], s66 offen offset:2048 sc1 lds
    buffer_load_dwordx4 v4, s[36:39], s66 offen offset:3072 sc1 lds
    s_add_u32 s66, s66, 8192
    v_mfma_f32_32x32x16_bf16 v[64:79], v[132:135], v[128:131], 0
    v_mfma_f32_32x32x16_bf16 v[64:79], v[140:143], v[136:139], v[64:79]
    v_mfma_f32_32x32x16_bf16 v[64:79], v[148:151], v[144:147], v[64:79]
    v_mfma_f32_32x32x16_bf16 v[64:79], v[156:159], v[152:155], v[64:79]
    s_waitcnt vmcnt(8)
    v_mov_b32 v30, 136244
    v_mov_b32 v31, 1
    s_mov_b64 exec, 1
    ds_add_rtn_u32 v31, v30, v31
    s_waitcnt lgkmcnt(0)
    s_mov_b64 exec, -1
    v_readfirstlane_b32 s61, v31
    s_nop 0
    s_cmp_lg_u32 s61, 3
    s_cbranch_scc1 k1_od
    s_lshl_b32 s61, s41, 7
    s_lshl_b32 s60, s42, 2
    s_add_u32 s61, s61, s60
    s_add_u32 s61, s61, 15212544
    v_mov_b32 v30, s61
    v_mov_b32 v31, 1
    s_mov_b64 exec, 1
    buffer_store_dword v31, v30, s[36:39], 0 offen sc1
    s_mov_b64 exec, -1
k1_od:
    s_waitcnt lgkmcnt(0)
    s_barrier
    ds_read_b128 v[128:131], v17 offset:0
    ds_read_b128 v[132:135], v20 offset:0
    ds_read_b128 v[136:139], v17 offset:1024
    ds_read_b128 v[140:143], v20 offset:1024
    ds_read_b128 v[144:147], v17 offset:2048
    ds_read_b128 v[148:151], v20 offset:2048
    ds_read_b128 v[152:155], v17 offset:3072
    ds_read_b128 v[156:159], v20 offset:3072
    s_add_u32 m0, s67, 32768
    s_nop 0
    buffer_load_dwordx4 v4, s[36:39], s66 offen offset:0 sc1 lds
    buffer_load_dwordx4 v4, s[36:39], s66 offen offset:1024 sc1 lds
    buffer_load_dwordx4 v4, s[36:39], s66 offen offset:2048 sc1 lds
    buffer_load_dwordx4 v4, s[36:39], s66 offen offset:3072 sc1 lds
    s_add_u32 s66, s66, 8192
    v_mfma_f32_32x32x16_bf16 v[64:79], v[164:167], v[160:163], v[64:79]
    v_mfma_f32_32x32x16_bf16 v[64:79], v[172:175], v[168:171], v[64:79]
    v_mfma_f32_32x32x16_bf16 v[64:79], v[180:183], v[176:179], v[64:79]
    v_mfma_f32_32x32x16_bf16 v[64:79], v[188:191], v[184:187], v[64:79]
    s_waitcnt vmcnt(8) lgkmcnt(0)
    s_barrier
    ds_read_b128 v[160:163], v17 offset:32768
    ds_read_b128 v[164:167], v20 offset:32768
    ds_read_b128 v[168:171], v17 offset:33792
    ds_read_b128 v[172:175], v20 offset:33792
    ds_read_b128 v[176:179], v17 offset:34816
    ds_read_b128 v[180:183], v20 offset:34816
    ds_read_b128 v[184:187], v17 offset:35840
    ds_read_b128 v[188:191], v20 offset:35840
    s_add_u32 m0, s67, 65536
    s_nop 0
    buffer_load_dwordx4 v4, s[36:39], s66 offen offset:0 sc1 lds
    buffer_load_dwordx4 v4, s[36:39], s66 offen offset:1024 sc1 lds
    buffer_load_dwordx4 v4, s[36:39], s66 offen offset:2048 sc1 lds
    buffer_load_dwordx4 v4, s[36:39], s66 offen offset:3072 sc1 lds
    s_add_u32 s66, s66, 8192
    v_mfma_f32_32x32x16_bf16 v[64:79], v[132:135], v[128:131], v[64:79]
    v_mfma_f32_32x32x16_bf16 v[64:79], v[140:143], v[136:139], v[64:79]
    v_mfma_f32_32x32x16_bf16 v[64:79], v[148:151], v[144:147], v[64:79]
    v_mfma_f32_32x32x16_bf16 v[64:79], v[156:159], v[152:155], v[64:79]
    s_waitcnt vmcnt(8) lgkmcnt(0)
    s_barrier
    ds_read_b128 v[128:131], v16 offset:0
    ds_read_b128 v[132:135], v19 offset:0
    ds_read_b128 v[136:139], v16 offset:1024
    ds_read_b128 v[140:143], v19 offset:1024
    ds_read_b128 v[144:147], v16 offset:2048
    ds_read_b128 v[148:151], v19 offset:2048
    ds_read_b128 v[152:155], v16 offset:3072
    ds_read_b128 v[156:159], v19 offset:3072
    s_add_u32 m0, s67, 98304
    s_nop 0
    buffer_load_dwordx4 v4, s[36:39], s66 offen offset:0 sc1 lds
    buffer_load_dwordx4 v4, s[36:39], s66 offen offset:1024 sc1 lds
    buffer_load_dwordx4 v4, s[36:39], s66 offen offset:2048 sc1 lds
    buffer_load_dwordx4 v4, s[36:39], s66 offen offset:3072 sc1 lds
    s_add_u32 s66, s66, 8192
    v_mfma_f32_32x32x16_bf16 v[64:79], v[164:167], v[160:163], v[64:79]
    v_mfma_f32_32x32x16_bf16 v[64:79], v[172:175], v[168:171], v[64:79]
    v_mfma_f32_32x32x16_bf16 v[64:79], v[180:183], v[176:179], v[64:79]
    v_mfma_f32_32x32x16_bf16 v[64:79], v[188:191], v[184:187], v[64:79]
    s_waitcnt vmcnt(8) lgkmcnt(0)
    s_barrier
    ds_read_b128 v[160:163], v16 offset:32768
    ds_read_b128 v[164:167], v19 offset:32768
    ds_read_b128 v[168:171], v16 offset:33792
    ds_read_b128 v[172:175], v19 offset:33792
    ds_read_b128 v[176:179], v16 offset:34816
    ds_read_b128 v[180:183], v19 offset:34816
    ds_read_b128 v[184:187], v16 offset:35840
    ds_read_b128 v[188:191], v19 offset:35840
    s_add_u32 m0, s67, 0
    s_nop 0
    buffer_load_dwordx4 v4, s[36:39], s66 offen offset:0 sc1 lds
    buffer_load_dwordx4 v4, s[36:39], s66 offen offset:1024 sc1 lds
    buffer_load_dwordx4 v4, s[36:39], s66 offen offset:2048 sc1 lds
    buffer_load_dwordx4 v4, s[36:39], s66 offen offset:3072 sc1 lds
    s_add_u32 s66, s66, 8192
    v_mfma_f32_32x32x16_bf16 v[64:79], v[132:135], v[128:131], v[64:79]
    v_mfma_f32_32x32x16_bf16 v[64:79], v[140:143], v[136:139], v[64:79]
    v_mfma_f32_32x32x16_bf16 v[64:79], v[148:151], v[144:147], v[64:79]
    v_mfma_f32_32x32x16_bf16 v[64:79], v[156:159], v[152:155], v[64:79]
    s_waitcnt vmcnt(8) lgkmcnt(0)
    s_barrier
    ds_read_b128 v[128:131], v17 offset:0
    ds_read_b128 v[132:135], v20 offset:0
    ds_read_b128 v[136:139], v17 offset:1024
    ds_read_b128 v[140:143], v20 offset:1024
    ds_read_b128 v[144:147], v17 offset:2048
    ds_read_b128 v[148:151], v20 offset:2048
    ds_read_b128 v[152:155], v17 offset:3072
    ds_read_b128 v[156:159], v20 offset:3072
    s_add_u32 m0, s67, 32768
    s_nop 0
    buffer_load_dwordx4 v4, s[36:39], s66 offen offset:0 sc1 lds
    buffer_load_dwordx4 v4, s[36:39], s66 offen offset:1024 sc1 lds
    buffer_load_dwordx4 v4, s[36:39], s66 offen offset:2048 sc1 lds
    buffer_load_dwordx4 v4, s[36:39], s66 offen offset:3072 sc1 lds
    s_add_u32 s66, s66, 8192
    v_mfma_f32_32x32x16_bf16 v[64:79], v[164:167], v[160:163], v[64:79]
    v_mfma_f32_32x32x16_bf16 v[64:79], v[172:175], v[168:171], v[64:79]
    v_mfma_f32_32x32x16_bf16 v[64:79], v[180:183], v[176:179], v[64:79]
    v_mfma_f32_32x32x16_bf16 v[64:79], v[188:191], v[184:187], v[64:79]
    s_waitcnt vmcnt(8) lgkmcnt(0)
    s_barrier
    ds_read_b128 v[160:163], v17 offset:32768
    ds_read_b128 v[164:167], v20 offset:32768
    ds_read_b128 v[168:171], v17 offset:33792
    ds_read_b128 v[172:175], v20 offset:33792
    ds_read_b128 v[176:179], v17 offset:34816
    ds_read_b128 v[180:183], v20 offset:34816
    ds_read_b128 v[184:187], v17 offset:35840
    ds_read_b128 v[188:191], v20 offset:35840
    s_add_u32 m0, s67, 65536
    s_nop 0
    buffer_load_dwordx4 v4, s[36:39], s66 offen offset:0 sc1 lds
    buffer_load_dwordx4 v4, s[36:39], s66 offen offset:1024 sc1 lds
    buffer_load_dwordx4 v4, s[36:39], s66 offen offset:2048 sc1 lds
    buffer_load_dwordx4 v4, s[36:39], s66 offen offset:3072 sc1 lds
    s_add_u32 s66, s66, 8192
    v_mfma_f32_32x32x16_bf16 v[64:79], v[132:135], v[128:131], v[64:79]
    v_mfma_f32_32x32x16_bf16 v[64:79], v[140:143], v[136:139], v[64:79]
    v_mfma_f32_32x32x16_bf16 v[64:79], v[148:151], v[144:147], v[64:79]
    v_mfma_f32_32x32x16_bf16 v[64:79], v[156:159], v[152:155], v[64:79]
    s_waitcnt vmcnt(8) lgkmcnt(0)
    s_barrier
    ds_read_b128 v[128:131], v16 offset:0
    ds_read_b128 v[132:135], v19 offset:0
    ds_read_b128 v[136:139], v16 offset:1024
    ds_read_b128 v[140:143], v19 offset:1024
    ds_read_b128 v[144:147], v16 offset:2048
    ds_read_b128 v[148:151], v19 offset:2048
    ds_read_b128 v[152:155], v16 offset:3072
    ds_read_b128 v[156:159], v19 offset:3072
    s_add_u32 m0, s67, 98304
    s_nop 0
    buffer_load_dwordx4 v4, s[36:39], s66 offen offset:0 sc1 lds
    buffer_load_dwordx4 v4, s[36:39], s66 offen offset:1024 sc1 lds
    buffer_load_dwordx4 v4, s[36:39], s66 offen offset:2048 sc1 lds
    buffer_load_dwordx4 v4, s[36:39], s66 offen offset:3072 sc1 lds
    s_add_u32 s66, s66, 8192
    v_mfma_f32_32x32x16_bf16 v[64:79], v[164:167], v[160:163], v[64:79]
    v_mfma_f32_32x32x16_bf16 v[64:79], v[172:175], v[168:171], v[64:79]
    v_mfma_f32_32x32x16_bf16 v[64:79], v[180:183], v[176:179], v[64:79]
    v_mfma_f32_32x32x16_bf16 v[64:79], v[188:191], v[184:187], v[64:79]
    s_waitcnt vmcnt(8) lgkmcnt(0)
    s_barrier
    ds_read_b128 v[160:163], v16 offset:32768
    ds_read_b128 v[164:167], v19 offset:32768
    ds_read_b128 v[168:171], v16 offset:33792
    ds_read_b128 v[172:175], v19 offset:33792
    ds_read_b128 v[176:179], v16 offset:34816
    ds_read_b128 v[180:183], v19 offset:34816
    ds_read_b128 v[184:187], v16 offset:35840
    ds_read_b128 v[188:191], v19 offset:35840
    s_add_u32 m0, s67, 0
    s_nop 0
    buffer_load_dwordx4 v4, s[36:39], s66 offen offset:0 sc1 lds
    buffer_load_dwordx4 v4, s[36:39], s66 offen offset:1024 sc1 lds
    buffer_load_dwordx4 v4, s[36:39], s66 offen offset:2048 sc1 lds
    buffer_load_dwordx4 v4, s[36:39], s66 offen offset:3072 sc1 lds
    s_add_u32 s66, s66, 8192
    buffer_load_dword v29, v28, s[36:39], s62 offen sc1
    v_mfma_f32_32x32x16_bf16 v[64:79], v[132:135], v[128:131], v[64:79]
    v_mfma_f32_32x32x16_bf16 v[64:79], v[140:143], v[136:139], v[64:79]
    v_mfma_f32_32x32x16_bf16 v[64:79], v[148:151], v[144:147], v[64:79]
    v_mfma_f32_32x32x16_bf16 v[64:79], v[156:159], v[152:155], v[64:79]
    s_waitcnt vmcnt(9) lgkmcnt(0)
    s_barrier
    ds_read_b128 v[128:131], v17 offset:0
    ds_read_b128 v[132:135], v20 offset:0
    ds_read_b128 v[136:139], v17 offset:1024
    ds_read_b128 v[140:143], v20 offset:1024
    ds_read_b128 v[144:147], v17 offset:2048
    ds_read_b128 v[148:151], v20 offset:2048
    ds_read_b128 v[152:155], v17 offset:3072
    ds_read_b128 v[156:159], v20 offset:3072
    s_add_u32 m0, s67, 32768
    s_nop 0
    buffer_load_dwordx4 v4, s[36:39], s66 offen offset:0 sc1 lds
    buffer_load_dwordx4 v4, s[36:39], s66 offen offset:1024 sc1 lds
    buffer_load_dwordx4 v4, s[36:39], s66 offen offset:2048 sc1 lds
    buffer_load_dwordx4 v4, s[36:39], s66 offen offset:3072 sc1 lds
    s_add_u32 s66, s66, 8192
    v_mfma_f32_32x32x16_bf16 v[64:79], v[164:167], v[160:163], v[64:79]
    v_mfma_f32_32x32x16_bf16 v[64:79], v[172:175], v[168:171], v[64:79]
    v_mfma_f32_32x32x16_bf16 v[64:79], v[180:183], v[176:179], v[64:79]
    v_mfma_f32_32x32x16_bf16 v[64:79], v[188:191], v[184:187], v[64:79]
    s_waitcnt vmcnt(9) lgkmcnt(0)
    s_barrier
    ds_read_b128 v[160:163], v17 offset:32768
    ds_read_b128 v[164:167], v20 offset:32768
    ds_read_b128 v[168:171], v17 offset:33792
    ds_read_b128 v[172:175], v20 offset:33792
    ds_read_b128 v[176:179], v17 offset:34816
    ds_read_b128 v[180:183], v20 offset:34816
    ds_read_b128 v[184:187], v17 offset:35840
    ds_read_b128 v[188:191], v20 offset:35840
    s_mov_b32 s61, 0
k2_polloB:
    s_waitcnt vmcnt(4)
    v_cmp_ne_u32 vcc, 1, v29
    s_add_u32 s61, s61, 1
    s_cmp_eq_u64 vcc, 0
    s_cbranch_scc1 k2_ookB
    buffer_load_dword v29, v28, s[36:39], s62 offen sc1
    s_waitcnt vmcnt(0)
    s_cmp_lt_u32 s61, 0x400000
    s_cbranch_scc1 k2_polloB
k2_ookB:
    s_add_u32 m0, s67, 65536
    s_nop 0
    buffer_load_dwordx4 v4, s[36:39], s66 offen offset:0 sc1 lds
    buffer_load_dwordx4 v4, s[36:39], s66 offen offset:1024 sc1 lds
    buffer_load_dwordx4 v4, s[36:39], s66 offen offset:2048 sc1 lds
    buffer_load_dwordx4 v4, s[36:39], s66 offen offset:3072 sc1 lds
    s_add_u32 s66, s66, 8192
    v_mfma_f32_32x32x16_bf16 v[64:79], v[132:135], v[128:131], v[64:79]
    v_mfma_f32_32x32x16_bf16 v[64:79], v[140:143], v[136:139], v[64:79]
    v_mfma_f32_32x32x16_bf16 v[64:79], v[148:151], v[144:147], v[64:79]
    v_mfma_f32_32x32x16_bf16 v[64:79], v[156:159], v[152:155], v[64:79]
    s_waitcnt vmcnt(9) lgkmcnt(0)
    s_barrier
    ds_read_b128 v[128:131], v16 offset:0
    ds_read_b128 v[132:135], v19 offset:0
    ds_read_b128 v[136:139], v16 offset:1024
    ds_read_b128 v[140:143], v19 offset:1024
    ds_read_b128 v[144:147], v16 offset:2048
    ds_read_b128 v[148:151], v19 offset:2048
    ds_read_b128 v[152:155], v16 offset:3072
    ds_read_b128 v[156:159], v19 offset:3072
    s_add_u32 m0, s67, 98304
    s_nop 0
    buffer_load_dwordx4 v4, s[36:39], s66 offen offset:0 sc1 lds
    buffer_load_dwordx4 v4, s[36:39], s66 offen offset:1024 sc1 lds
    buffer_load_dwordx4 v4, s[36:39], s66 offen offset:2048 sc1 lds
    buffer_load_dwordx4 v4, s[36:39], s66 offen offset:3072 sc1 lds
    s_add_u32 s66, s66, 8192
    v_mfma_f32_32x32x16_bf16 v[64:79], v[164:167], v[160:163], v[64:79]
    v_mfma_f32_32x32x16_bf16 v[64:79], v[172:175], v[168:171], v[64:79]
    v_mfma_f32_32x32x16_bf16 v[64:79], v[180:183], v[176:179], v[64:79]
    v_mfma_f32_32x32x16_bf16 v[64:79], v[188:191], v[184:187], v[64:79]
    s_waitcnt vmcnt(8) lgkmcnt(0)
    s_barrier
    ds_read_b128 v[160:163], v16 offset:32768
    ds_read_b128 v[164:167], v19 offset:32768
    ds_read_b128 v[168:171], v16 offset:33792
    ds_read_b128 v[172:175], v19 offset:33792
    ds_read_b128 v[176:179], v16 offset:34816
    ds_read_b128 v[180:183], v19 offset:34816
    ds_read_b128 v[184:187], v16 offset:35840
    ds_read_b128 v[188:191], v19 offset:35840
    s_add_u32 m0, s67, 0
    s_nop 0
    buffer_load_dwordx4 v4, s[36:39], s66 offen offset:0 sc1 lds
    buffer_load_dwordx4 v4, s[36:39], s66 offen offset:1024 sc1 lds
    buffer_load_dwordx4 v4, s[36:39], s66 offen offset:2048 sc1 lds
    buffer_load_dwordx4 v4, s[36:39], s66 offen offset:3072 sc1 lds
    s_add_u32 s66, s66, 8192
    v_mfma_f32_32x32x16_bf16 v[64:79], v[132:135], v[128:131], v[64:79]
    v_mfma_f32_32x32x16_bf16 v[64:79], v[140:143], v[136:139], v[64:79]
    v_mfma_f32_32x32x16_bf16 v[64:79], v[148:151], v[144:147], v[64:79]
    v_mfma_f32_32x32x16_bf16 v[64:79], v[156:159], v[152:155], v[64:79]
    s_waitcnt vmcnt(8) lgkmcnt(0)
    s_barrier
    ds_read_b128 v[128:131], v17 offset:0
    ds_read_b128 v[132:135], v20 offset:0
    ds_read_b128 v[136:139], v17 offset:1024
    ds_read_b128 v[140:143], v20 offset:1024
    ds_read_b128 v[144:147], v17 offset:2048
    ds_read_b128 v[148:151], v20 offset:2048
    ds_read_b128 v[152:155], v17 offset:3072
    ds_read_b128 v[156:159], v20 offset:3072
    s_add_u32 m0, s67, 32768
    s_nop 0
    buffer_load_dwordx4 v4, s[36:39], s66 offen offset:0 sc1 lds
    buffer_load_dwordx4 v4, s[36:39], s66 offen offset:1024 sc1 lds
    buffer_load_dwordx4 v4, s[36:39], s66 offen offset:2048 sc1 lds
    buffer_load_dwordx4 v4, s[36:39], s66 offen offset:3072 sc1 lds
    s_add_u32 s66, s66, 8192
    buffer_load_dwordx4 v[8:11], v6, s[4:7], 0 offen
    buffer_load_dwordx4 v[12:15], v5, s[28:31], 0 offen
    v_mfma_f32_32x32x16_bf16 v[64:79], v[164:167], v[160:163], v[64:79]
    v_mfma_f32_32x32x16_bf16 v[64:79], v[172:175], v[168:171], v[64:79]
    v_mfma_f32_32x32x16_bf16 v[64:79], v[180:183], v[176:179], v[64:79]
    v_mfma_f32_32x32x16_bf16 v[64:79], v[188:191], v[184:187], v[64:79]
    s_waitcnt vmcnt(10) lgkmcnt(0)
    s_barrier
    ds_read_b128 v[160:163], v17 offset:32768
    ds_read_b128 v[164:167], v20 offset:32768
    ds_read_b128 v[168:171], v17 offset:33792
    ds_read_b128 v[172:175], v20 offset:33792
    ds_read_b128 v[176:179], v17 offset:34816
    ds_read_b128 v[180:183], v20 offset:34816
    ds_read_b128 v[184:187], v17 offset:35840
    ds_read_b128 v[188:191], v20 offset:35840
    v_mfma_f32_32x32x16_bf16 v[80:95], v[132:135], v[128:131], 0
    v_mfma_f32_32x32x16_bf16 v[80:95], v[140:143], v[136:139], v[80:95]
    v_mfma_f32_32x32x16_bf16 v[80:95], v[148:151], v[144:147], v[80:95]
    v_mfma_f32_32x32x16_bf16 v[80:95], v[156:159], v[152:155], v[80:95]
    s_waitcnt vmcnt(6) lgkmcnt(0)
    s_barrier
    ds_read_b128 v[128:131], v16 offset:0
    ds_read_b128 v[132:135], v19 offset:0
    ds_read_b128 v[136:139], v16 offset:1024
    ds_read_b128 v[140:143], v19 offset:1024
    ds_read_b128 v[144:147], v16 offset:2048
    ds_read_b128 v[148:151], v19 offset:2048
    ds_read_b128 v[152:155], v16 offset:3072
    ds_read_b128 v[156:159], v19 offset:3072
    v_mfma_f32_32x32x16_bf16 v[80:95], v[164:167], v[160:163], v[80:95]
    v_mfma_f32_32x32x16_bf16 v[80:95], v[172:175], v[168:171], v[80:95]
    v_mfma_f32_32x32x16_bf16 v[80:95], v[180:183], v[176:179], v[80:95]
    v_mfma_f32_32x32x16_bf16 v[80:95], v[188:191], v[184:187], v[80:95]
    s_waitcnt vmcnt(2) lgkmcnt(0)
    s_barrier
    ds_read_b128 v[160:163], v16 offset:32768
    ds_read_b128 v[164:167], v19 offset:32768
    ds_read_b128 v[168:171], v16 offset:33792
    ds_read_b128 v[172:175], v19 offset:33792
    ds_read_b128 v[176:179], v16 offset:34816
    ds_read_b128 v[180:183], v19 offset:34816
    ds_read_b128 v[184:187], v16 offset:35840
    ds_read_b128 v[188:191], v19 offset:35840
    v_mfma_f32_32x32x16_bf16 v[80:95], v[132:135], v[128:131], v[80:95]
    v_mfma_f32_32x32x16_bf16 v[80:95], v[140:143], v[136:139], v[80:95]
    v_mfma_f32_32x32x16_bf16 v[80:95], v[148:151], v[144:147], v[80:95]
    v_mfma_f32_32x32x16_bf16 v[80:95], v[156:159], v[152:155], v[80:95]
    s_waitcnt lgkmcnt(6)
    v_mfma_f32_32x32x16_bf16 v[80:95], v[164:167], v[160:163], v[80:95]
    s_waitcnt lgkmcnt(4)
    v_mfma_f32_32x32x16_bf16 v[80:95], v[172:175], v[168:171], v[80:95]
    s_waitcnt lgkmcnt(2)
    v_mfma_f32_32x32x16_bf16 v[80:95], v[180:183], v[176:179], v[80:95]
    s_waitcnt lgkmcnt(0)
    v_mfma_f32_32x32x16_bf16 v[80:95], v[188:191], v[184:187], v[80:95]
    s_barrier
    s_mov_b32 s60, 0xbfb8aa3b
    ds_write_b128 v22, v[64:67] offset:0
    ds_write_b128 v22, v[68:71] offset:1024
    s_nop 7
    ds_write_b128 v22, v[80:83] offset:2048
    ds_write_b128 v22, v[84:87] offset:3072
    s_waitcnt lgkmcnt(0)
    s_barrier
    ds_read_b128 v[96:99], v23 offset:0
    ds_read_b128 v[100:103], v23 offset:1024
    ds_read_b128 v[104:107], v23 offset:2048
    ds_read_b128 v[108:111], v23 offset:3072
    s_waitcnt lgkmcnt(3)
    v_add_f32 v72, v72, v96
    v_add_f32 v73, v73, v97
    v_add_f32 v74, v74, v98
    v_add_f32 v75, v75, v99
    s_waitcnt lgkmcnt(2)
    v_add_f32 v76, v76, v100
    v_add_f32 v77, v77, v101
    v_add_f32 v78, v78, v102
    v_add_f32 v79, v79, v103
    s_waitcnt lgkmcnt(1)
    v_add_f32 v88, v88, v104
    v_add_f32 v89, v89, v105
    v_add_f32 v90, v90, v106
    v_add_f32 v91, v91, v107
    s_waitcnt lgkmcnt(0)
    v_add_f32 v92, v92, v108
    v_add_f32 v93, v93, v109
    v_add_f32 v94, v94, v110
    v_add_f32 v95, v95, v111
    v_cvt_pk_bf16_f32 v112, v72, v73
    v_lshlrev_b32 v72, 16, v112
    v_and_b32 v73, s48, v112
    v_cvt_pk_bf16_f32 v116, v74, v75
    v_lshlrev_b32 v74, 16, v116
    v_and_b32 v75, s48, v116
    v_cvt_pk_bf16_f32 v120, v76, v77
    v_lshlrev_b32 v76, 16, v120
    v_and_b32 v77, s48, v120
    v_cvt_pk_bf16_f32 v124, v78, v79
    v_lshlrev_b32 v78, 16, v124
    v_and_b32 v79, s48, v124
    s_waitcnt vmcnt(0)
    v_lshlrev_b32 v113, 16, v12
    v_and_b32 v114, s48, v12
    v_add_f32 v72, v72, v113
    v_add_f32 v73, v73, v114
    v_lshlrev_b32 v117, 16, v13
    v_and_b32 v118, s48, v13
    v_add_f32 v74, v74, v117
    v_add_f32 v75, v75, v118
    v_lshlrev_b32 v121, 16, v14
    v_and_b32 v122, s48, v14
    v_add_f32 v76, v76, v121
    v_add_f32 v77, v77, v122
    v_lshlrev_b32 v125, 16, v15
    v_and_b32 v126, s48, v15
    v_add_f32 v78, v78, v125
    v_add_f32 v79, v79, v126
    v_cvt_pk_bf16_f32 v112, v72, v73
    v_lshlrev_b32 v72, 16, v112
    v_and_b32 v73, s48, v112
    v_cvt_pk_bf16_f32 v116, v74, v75
    v_lshlrev_b32 v74, 16, v116
    v_and_b32 v75, s48, v116
    v_cvt_pk_bf16_f32 v120, v76, v77
    v_lshlrev_b32 v76, 16, v120
    v_and_b32 v77, s48, v120
    v_cvt_pk_bf16_f32 v124, v78, v79
    v_lshlrev_b32 v78, 16, v124
    v_and_b32 v79, s48, v124
    v_mul_f32 v113, s60, v72
    v_mul_f32 v114, s60, v73
    v_exp_f32 v113, v113
    v_exp_f32 v114, v114
    v_mul_f32 v117, s60, v74
    v_mul_f32 v118, s60, v75
    v_exp_f32 v117, v117
    v_exp_f32 v118, v118
    v_mul_f32 v121, s60, v76
    v_mul_f32 v122, s60, v77
    v_exp_f32 v121, v121
    v_exp_f32 v122, v122
    v_mul_f32 v125, s60, v78
    v_mul_f32 v126, s60, v79
    v_exp_f32 v125, v125
    v_exp_f32 v126, v126
    v_add_f32 v113, 1.0, v113
    v_add_f32 v114, 1.0, v114
    v_rcp_f32 v113, v113
    v_rcp_f32 v114, v114
    v_add_f32 v117, 1.0, v117
    v_add_f32 v118, 1.0, v118
    v_rcp_f32 v117, v117
    v_rcp_f32 v118, v118
    v_add_f32 v121, 1.0, v121
    v_add_f32 v122, 1.0, v122
    v_rcp_f32 v121, v121
    v_rcp_f32 v122, v122
    v_add_f32 v125, 1.0, v125
    v_add_f32 v126, 1.0, v126
    v_rcp_f32 v125, v125
    v_rcp_f32 v126, v126
    v_mul_f32 v72, v72, v113
    v_mul_f32 v73, v73, v114
    v_cvt_pk_bf16_f32 v115, v88, v89
    v_lshlrev_b32 v88, 16, v115
    v_and_b32 v89, s48, v115
    v_mul_f32 v74, v74, v117
    v_mul_f32 v75, v75, v118
    v_cvt_pk_bf16_f32 v119, v90, v91
    v_lshlrev_b32 v90, 16, v119
    v_and_b32 v91, s48, v119
    v_mul_f32 v76, v76, v121
    v_mul_f32 v77, v77, v122
    v_cvt_pk_bf16_f32 v123, v92, v93
    v_lshlrev_b32 v92, 16, v123
    v_and_b32 v93, s48, v123
    v_mul_f32 v78, v78, v125
    v_mul_f32 v79, v79, v126
    v_cvt_pk_bf16_f32 v127, v94, v95
    v_lshlrev_b32 v94, 16, v127
    v_and_b32 v95, s48, v127
    v_cvt_pk_bf16_f32 v112, v72, v73
    v_lshlrev_b32 v72, 16, v112
    v_and_b32 v73, s48, v112
    v_cvt_pk_bf16_f32 v116, v74, v75
    v_lshlrev_b32 v74, 16, v116
    v_and_b32 v75, s48, v116
    v_cvt_pk_bf16_f32 v120, v76, v77
    v_lshlrev_b32 v76, 16, v120
    v_and_b32 v77, s48, v120
    v_cvt_pk_bf16_f32 v124, v78, v79
    v_lshlrev_b32 v78, 16, v124
    v_and_b32 v79, s48, v124
    v_mul_f32 v72, v72, v88
    v_mul_f32 v73, v73, v89
    v_mul_f32 v74, v74, v90
    v_mul_f32 v75, v75, v91
    v_mul_f32 v76, v76, v92
    v_mul_f32 v77, v77, v93
    v_mul_f32 v78, v78, v94
    v_mul_f32 v79, v79, v95
    v_cvt_pk_bf16_f32 v112, v72, v73
    v_lshlrev_b32 v72, 16, v112
    v_and_b32 v73, s48, v112
    v_cvt_pk_bf16_f32 v116, v74, v75
    v_lshlrev_b32 v74, 16, v116
    v_and_b32 v75, s48, v116
    v_cvt_pk_bf16_f32 v120, v76, v77
    v_lshlrev_b32 v76, 16, v120
    v_and_b32 v77, s48, v120
    v_cvt_pk_bf16_f32 v124, v78, v79
    v_lshlrev_b32 v78, 16, v124
    v_and_b32 v79, s48, v124
    v_lshlrev_b32 v113, 16, v8
    v_and_b32 v114, s48, v8
    v_add_f32 v72, v72, v113
    v_add_f32 v73, v73, v114
    v_cvt_pk_bf16_f32 v24, v72, v73
    v_lshlrev_b32 v117, 16, v9
    v_and_b32 v118, s48, v9
    v_add_f32 v74, v74, v117
    v_add_f32 v75, v75, v118
    v_cvt_pk_bf16_f32 v25, v74, v75
    v_lshlrev_b32 v121, 16, v10
    v_and_b32 v122, s48, v10
    v_add_f32 v76, v76, v121
    v_add_f32 v77, v77, v122
    v_cvt_pk_bf16_f32 v26, v76, v77
    v_lshlrev_b32 v125, 16, v11
    v_and_b32 v126, s48, v11
    v_add_f32 v78, v78, v125
    v_add_f32 v79, v79, v126
    v_cvt_pk_bf16_f32 v27, v78, v79
    buffer_store_dwordx4 v[24:27], v6, s[16:19], 0 offen
    s_endpgm
k1_end:
    s_endpgm
.section .rodata,"a"
.p2align 6
.amdhsa_kernel recurrent_scan__linear_kernel_hedgehog__dense_activation_squared_relu__prompt_kernel
  .amdhsa_next_free_vgpr 256
  .amdhsa_next_free_sgpr 102
  .amdhsa_accum_offset 256
  .amdhsa_group_segment_fixed_size 0
  .amdhsa_kernarg_size 96
  .amdhsa_user_sgpr_count 2
  .amdhsa_user_sgpr_kernarg_segment_ptr 1
  .amdhsa_system_sgpr_workgroup_id_x 1
  .amdhsa_float_denorm_mode_32 3
.end_amdhsa_kernel
```
